```python
import torch

def _softmax(x, axis=-1):
    return torch.softmax(x, dim=axis)
def _gelu(x):
    return torch.nn.functional.gelu(x, approximate="tanh")
def _silu(x):
    return torch.nn.functional.silu(x)
def _sigmoid(x):
    return torch.sigmoid(x)
def _layernorm(x, axis=-1, eps=1e-5):
    m = x.mean(dim=axis, keepdim=True)
    v = x.var(dim=axis, keepdim=True, unbiased=False)
    return (x - m) / torch.sqrt(v + eps)
def _scatter_add(tgt, idx, src, axis=0):
    return tgt.clone().index_add_(axis, idx, src)
def _segment_sum(src, seg, n):
    out = torch.zeros((n,) + src.shape[1:], dtype=src.dtype)
    return out.index_add_(0, seg, src)
def _pad(x, pw):
    flat = tuple(v for pair in reversed(pw) for v in pair)
    return torch.nn.functional.pad(x, flat)

kernel_name = 'standalone__softmax_full_causal__prompt'

def setup_inputs():

    _w = (lambda a: (lambda t: t.to(torch.bfloat16) if t.is_floating_point() else t)(torch.as_tensor(a)))
    B, H, S, D = 1, 32, 2048, 128
    return {
        "q": _w((lambda *s: torch.randn(*s, dtype=torch.bfloat16) * 0.8)(B, H, S, D)),
        "k": _w((lambda *s: torch.randn(*s, dtype=torch.bfloat16) * 0.8)(B, H, S, D)),
        "v": _w((lambda *s: torch.randn(*s, dtype=torch.bfloat16) * 0.05)(B, H, S, D)),
    }

def reference(q, k, v):
    B, H, S, D = q.shape[0], q.shape[1], q.shape[2], q.shape[3]
    scale = D ** -0.5
    scores = torch.einsum('bhqd,bhkd->bhqk', q, k) * scale
    qi = torch.reshape(torch.arange(S), (1, 1, S, 1))
    kj = torch.reshape(torch.arange(S), (1, 1, 1, S))
    causal_bias = (lambda x, dt: x.to(dt))(kj > qi, scores.dtype) * (-1e9)
    attn = _softmax(scores + causal_bias, axis=-1)
    return torch.einsum('bhqk,bhkd->bhqd', attn, v)
```

```asm
; @launch grid=(256,1,1) block=(512,1,1) lds=152832
.amdgcn_target "amdgcn-amd-amdhsa--gfx950"
.text
.globl standalone__softmax_full_causal__prompt_kernel
.p2align 8
.type standalone__softmax_full_causal__prompt_kernel,@function
standalone__softmax_full_causal__prompt_kernel:
    s_cmp_ge_u32 s2, 256
    s_cbranch_scc1 L_end
    s_load_dwordx4 s[4:7], s[0:1], 0
    s_load_dwordx4 s[8:11], s[0:1], 16
    v_lshrrev_b32 v238, 6, v0
    v_and_b32 v239, 63, v0
    v_readfirstlane_b32 s28, v238
    s_and_b32 s29, s2, 7
    s_lshl_b32 s29, s29, 2
    s_lshr_b32 s45, s2, 3
    s_and_b32 s45, s45, 3
    s_add_u32 s29, s29, s45
    s_lshr_b32 s30, s2, 5
    s_lshl_b32 s45, s30, 1
    s_sub_u32 s34, 32, s45
    s_lshl_b32 s45, s30, 2
    s_add_u32 s31, s45, s28
    s_sub_u32 s46, 67, s45
    s_sub_u32 s46, s46, s28
    s_cmp_lt_u32 s28, 4
    s_cselect_b32 s33, 1, 0
    s_cselect_b32 s31, s31, s46
    s_lshl_b32 s45, s31, 13
    s_add_u32 s31, s31, 1
    v_and_b32 v240, 31, v239
    v_lshrrev_b32 v241, 5, v239
    v_lshlrev_b32 v235, 8, v240
    v_lshl_add_u32 v235, v241, 4, v235
    v_add_u32 v235, s45, v235
    v_lshlrev_b32 v237, 2, v241
    v_sub_u32 v237, v240, v237
    v_lshrrev_b32 v238, 4, v239
    v_and_b32 v240, 15, v239
    v_lshlrev_b32 v236, 12, v238
    v_lshl_add_u32 v236, v240, 4, v236
    s_and_b32 s45, s28, 3
    s_lshl_b32 s46, s45, 10
    v_add_u32 v236, s46, v236
    s_mul_i32 s47, s45, 4160
    s_mul_i32 s48, s45, 4352
    v_mul_u32_u24 v233, 1040, v240
    v_and_b32 v238, 1, v238
    v_lshl_add_u32 v233, v238, 8, v233
    v_lshl_add_u32 v233, v241, 4, v233
    v_lshrrev_b32 v240, 2, v240
    v_lshl_add_u32 v240, v241, 2, v240
    v_mul_u32_u24 v234, 1088, v240
    v_lshl_add_u32 v234, v238, 5, v234
    v_and_b32 v240, 3, v239
    v_lshl_add_u32 v234, v240, 3, v234
    v_add_u32 v234, 66560, v234
    v_mov_b32 v231, v233
    v_mov_b32 v232, v234
    s_mov_b32 s42, 0x3e0293ee
    s_mov_b32 s43, 0x47800000
    s_mov_b32 s44, 0xf149f2ca
    s_mov_b32 s35, 0
    s_mov_b32 s36, 0
    s_mov_b32 s37, 0
    s_mov_b32 s49, 3
    s_lshl_b32 s45, s29, 19
    s_lshl_b32 s46, s34, 14
    s_waitcnt lgkmcnt(0)
    s_add_u32 s12, s4, s45
    s_addc_u32 s13, s5, 0
    s_and_b32 s13, s13, 0xffff
    s_mov_b32 s14, 524288
    s_mov_b32 s15, 0x00020000
    s_add_u32 s16, s6, s45
    s_addc_u32 s17, s7, 0
    s_and_b32 s17, s17, 0xffff
    s_mov_b32 s18, s46
    s_mov_b32 s19, 0x00020000
    s_add_u32 s20, s8, s45
    s_addc_u32 s21, s9, 0
    s_and_b32 s21, s21, 0xffff
    s_mov_b32 s22, s46
    s_mov_b32 s23, 0x00020000
    s_add_u32 s24, s10, s45
    s_addc_u32 s25, s11, 0
    s_and_b32 s25, s25, 0xffff
    s_mov_b32 s26, 524288
    s_mov_b32 s27, 0x00020000
    v_and_b32 v239, 63, v0
    s_sub_u32 s45, s31, 1
    s_lshl_b32 s45, s45, 13
    v_lshlrev_b32 v240, 4, v239
    v_add_u32 v240, s45, v240
    v_bfe_u32 v238, v239, 2, 3
    v_mul_u32_u24 v241, 1040, v238
    v_and_b32 v238, 3, v239
    v_lshl_add_u32 v241, v238, 8, v241
    v_lshrrev_b32 v238, 5, v239
    v_lshl_add_u32 v241, v238, 4, v241
    s_cmp_eq_u32 s33, 0
    s_cbranch_scc1 L_proB
    s_mov_b32 s38, 0
    s_add_u32 m0, s38, s47
    s_nop 0
    buffer_load_dwordx4 v236, s[16:19], s36 offen offset:0 lds
    s_add_u32 m0, m0, 784
    s_nop 0
    buffer_load_dwordx4 v236, s[16:19], s36 offen offset:256 lds
    s_add_u32 m0, m0, 784
    s_nop 0
    buffer_load_dwordx4 v236, s[16:19], s36 offen offset:512 lds
    s_add_u32 m0, m0, 784
    s_nop 0
    buffer_load_dwordx4 v236, s[16:19], s36 offen offset:768 lds
    s_add_u32 s36, s36, 16384
    s_mul_i32 s45, s28, 8320
    s_add_u32 s46, s45, 84736
    s_add_u32 s32, s45, 86272
    s_add_u32 s45, s45, 49920
    s_cmp_ge_u32 s28, 2
    s_cselect_b32 s45, s46, s45
    s_cmp_ge_u32 s28, 6
    s_cselect_b32 s45, s32, s45
    s_mov_b32 s46, 4096
    s_add_u32 m0, s45, 0
    s_nop 0
    buffer_load_dwordx4 v240, s[12:15], 0 offen offset:0 lds
    s_add_u32 m0, s45, 16
    s_nop 0
    buffer_load_dwordx4 v240, s[12:15], 0 offen offset:1024 lds
    s_add_u32 m0, s45, 32
    s_nop 0
    buffer_load_dwordx4 v240, s[12:15], 0 offen offset:2048 lds
    s_add_u32 m0, s45, 48
    s_nop 0
    buffer_load_dwordx4 v240, s[12:15], 0 offen offset:3072 lds
    s_add_u32 m0, s45, 4160
    s_nop 0
    buffer_load_dwordx4 v240, s[12:15], s46 offen offset:0 lds
    s_add_u32 m0, s45, 4176
    s_nop 0
    buffer_load_dwordx4 v240, s[12:15], s46 offen offset:1024 lds
    s_add_u32 m0, s45, 4192
    s_nop 0
    buffer_load_dwordx4 v240, s[12:15], s46 offen offset:2048 lds
    s_add_u32 m0, s45, 4208
    s_nop 0
    buffer_load_dwordx4 v240, s[12:15], s46 offen offset:3072 lds
    v_add_u32 v241, s45, v241
    v_mov_b32 v0, 0
    v_mov_b32 v1, 0
    v_mov_b32 v2, 0
    v_mov_b32 v3, 0
    v_mov_b32 v4, 0
    v_mov_b32 v5, 0
    v_mov_b32 v6, 0
    v_mov_b32 v7, 0
    v_mov_b32 v8, 0
    v_mov_b32 v9, 0
    v_mov_b32 v10, 0
    v_mov_b32 v11, 0
    v_mov_b32 v12, 0
    v_mov_b32 v13, 0
    v_mov_b32 v14, 0
    v_mov_b32 v15, 0
    v_mov_b32 v16, 0
    v_mov_b32 v17, 0
    v_mov_b32 v18, 0
    v_mov_b32 v19, 0
    v_mov_b32 v20, 0
    v_mov_b32 v21, 0
    v_mov_b32 v22, 0
    v_mov_b32 v23, 0
    v_mov_b32 v24, 0
    v_mov_b32 v25, 0
    v_mov_b32 v26, 0
    v_mov_b32 v27, 0
    v_mov_b32 v28, 0
    v_mov_b32 v29, 0
    v_mov_b32 v30, 0
    v_mov_b32 v31, 0
    v_mov_b32 v32, 0
    v_mov_b32 v33, 0
    v_mov_b32 v34, 0
    v_mov_b32 v35, 0
    v_mov_b32 v36, 0
    v_mov_b32 v37, 0
    v_mov_b32 v38, 0
    v_mov_b32 v39, 0
    v_mov_b32 v40, 0
    v_mov_b32 v41, 0
    v_mov_b32 v42, 0
    v_mov_b32 v43, 0
    v_mov_b32 v44, 0
    v_mov_b32 v45, 0
    v_mov_b32 v46, 0
    v_mov_b32 v47, 0
    v_mov_b32 v48, 0
    v_mov_b32 v49, 0
    v_mov_b32 v50, 0
    v_mov_b32 v51, 0
    v_mov_b32 v52, 0
    v_mov_b32 v53, 0
    v_mov_b32 v54, 0
    v_mov_b32 v55, 0
    v_mov_b32 v56, 0
    v_mov_b32 v57, 0
    v_mov_b32 v58, 0
    v_mov_b32 v59, 0
    v_mov_b32 v60, 0
    v_mov_b32 v61, 0
    v_mov_b32 v62, 0
    v_mov_b32 v63, 0
    v_mov_b32 v144, 0
    v_mov_b32 v145, 0
    v_mov_b32 v146, 0
    v_mov_b32 v147, 0
    v_mov_b32 v148, 0
    v_mov_b32 v149, 0
    v_mov_b32 v150, 0
    v_mov_b32 v151, 0
    v_mov_b32 v152, 0
    v_mov_b32 v153, 0
    v_mov_b32 v154, 0
    v_mov_b32 v155, 0
    v_mov_b32 v156, 0
    v_mov_b32 v157, 0
    v_mov_b32 v158, 0
    v_mov_b32 v159, 0
    s_cmp_lg_u32 s31, 1
    s_cbranch_scc1 L_nomask0
    v_cmp_gt_i32 s[50:51], 0, v237
    v_cmp_gt_i32 s[52:53], 1, v237
    v_cmp_gt_i32 s[54:55], 2, v237
    v_cmp_gt_i32 s[56:57], 3, v237
    v_cmp_gt_i32 s[58:59], 8, v237
    v_cmp_gt_i32 s[60:61], 9, v237
    v_cmp_gt_i32 s[62:63], 10, v237
    v_cmp_gt_i32 s[64:65], 11, v237
    v_cmp_gt_i32 s[66:67], 16, v237
    v_cmp_gt_i32 s[68:69], 17, v237
    v_cmp_gt_i32 s[70:71], 18, v237
    v_cmp_gt_i32 s[72:73], 19, v237
    v_cmp_gt_i32 s[74:75], 24, v237
    v_cmp_gt_i32 s[76:77], 25, v237
    v_cmp_gt_i32 s[78:79], 26, v237
    v_cmp_gt_i32 s[80:81], 27, v237
    v_mov_b32 v238, s44
    s_nop 1
    v_cndmask_b32 v144, v144, v238, s[50:51]
    v_cndmask_b32 v145, v145, v238, s[52:53]
    v_cndmask_b32 v146, v146, v238, s[54:55]
    v_cndmask_b32 v147, v147, v238, s[56:57]
    v_cndmask_b32 v148, v148, v238, s[58:59]
    v_cndmask_b32 v149, v149, v238, s[60:61]
    v_cndmask_b32 v150, v150, v238, s[62:63]
    v_cndmask_b32 v151, v151, v238, s[64:65]
    v_cndmask_b32 v152, v152, v238, s[66:67]
    v_cndmask_b32 v153, v153, v238, s[68:69]
    v_cndmask_b32 v154, v154, v238, s[70:71]
    v_cndmask_b32 v155, v155, v238, s[72:73]
    v_cndmask_b32 v156, v156, v238, s[74:75]
    v_cndmask_b32 v157, v157, v238, s[76:77]
    v_cndmask_b32 v158, v158, v238, s[78:79]
    v_cndmask_b32 v159, v159, v238, s[80:81]
    s_nop 1
L_nomask0:
    s_waitcnt vmcnt(8)
    s_barrier
    s_mov_b32 s38, 16640
    s_add_u32 m0, s38, s47
    s_nop 0
    buffer_load_dwordx4 v236, s[16:19], s36 offen offset:0 lds
    s_add_u32 m0, m0, 784
    s_nop 0
    buffer_load_dwordx4 v236, s[16:19], s36 offen offset:256 lds
    s_add_u32 m0, m0, 784
    s_nop 0
    buffer_load_dwordx4 v236, s[16:19], s36 offen offset:512 lds
    s_add_u32 m0, m0, 784
    s_nop 0
    buffer_load_dwordx4 v236, s[16:19], s36 offen offset:768 lds
    s_add_u32 s36, s36, 16384
    s_mov_b32 s39, 66560
    s_add_u32 m0, s39, s48
    s_nop 0
    buffer_load_dwordx4 v236, s[20:23], s37 offen offset:0 lds
    s_add_u32 m0, m0, 832
    s_nop 0
    buffer_load_dwordx4 v236, s[20:23], s37 offen offset:256 lds
    s_add_u32 m0, m0, 832
    s_nop 0
    buffer_load_dwordx4 v236, s[20:23], s37 offen offset:512 lds
    s_add_u32 m0, m0, 832
    s_nop 0
    buffer_load_dwordx4 v236, s[20:23], s37 offen offset:768 lds
    s_add_u32 s37, s37, 16384
    s_mov_b32 s38, 33280
    s_add_u32 m0, s38, s47
    s_nop 0
    buffer_load_dwordx4 v236, s[16:19], s36 offen offset:0 lds
    s_add_u32 m0, m0, 784
    s_nop 0
    buffer_load_dwordx4 v236, s[16:19], s36 offen offset:256 lds
    s_add_u32 m0, m0, 784
    s_nop 0
    buffer_load_dwordx4 v236, s[16:19], s36 offen offset:512 lds
    s_add_u32 m0, m0, 784
    s_nop 0
    buffer_load_dwordx4 v236, s[16:19], s36 offen offset:768 lds
    s_add_u32 s36, s36, 16384
    s_mov_b32 s39, 83968
    s_add_u32 m0, s39, s48
    s_nop 0
    buffer_load_dwordx4 v236, s[20:23], s37 offen offset:0 lds
    s_add_u32 m0, m0, 832
    s_nop 0
    buffer_load_dwordx4 v236, s[20:23], s37 offen offset:256 lds
    s_add_u32 m0, m0, 832
    s_nop 0
    buffer_load_dwordx4 v236, s[20:23], s37 offen offset:512 lds
    s_add_u32 m0, m0, 832
    s_nop 0
    buffer_load_dwordx4 v236, s[20:23], s37 offen offset:768 lds
    s_add_u32 s37, s37, 16384
    ds_read_b128 v[160:163], v231 offset:0
    ds_read_b128 v[164:167], v231 offset:32
    ds_read_b128 v[168:171], v231 offset:64
    ds_read_b128 v[172:175], v231 offset:96
    ds_read_b128 v[176:179], v231 offset:128
    ds_read_b128 v[180:183], v231 offset:160
    ds_read_b128 v[184:187], v231 offset:192
    ds_read_b128 v[188:191], v231 offset:224
    ds_read_b128 v[192:195], v231 offset:512
    ds_read_b128 v[196:199], v231 offset:544
    ds_read_b128 v[200:203], v231 offset:576
    ds_read_b128 v[204:207], v231 offset:608
    ds_read_b128 v[208:211], v231 offset:640
    ds_read_b128 v[212:215], v231 offset:672
    ds_read_b128 v[216:219], v231 offset:704
    ds_read_b128 v[220:223], v231 offset:736
    s_waitcnt vmcnt(16)
    s_branch L_wqJ
L_proB:
    s_mul_i32 s45, s28, 8320
    s_add_u32 s46, s45, 84736
    s_add_u32 s32, s45, 86272
    s_add_u32 s45, s45, 49920
    s_cmp_ge_u32 s28, 2
    s_cselect_b32 s45, s46, s45
    s_cmp_ge_u32 s28, 6
    s_cselect_b32 s45, s32, s45
    s_mov_b32 s46, 4096
    s_add_u32 m0, s45, 0
    s_nop 0
    buffer_load_dwordx4 v240, s[12:15], 0 offen offset:0 lds
    s_add_u32 m0, s45, 16
    s_nop 0
    buffer_load_dwordx4 v240, s[12:15], 0 offen offset:1024 lds
    s_add_u32 m0, s45, 32
    s_nop 0
    buffer_load_dwordx4 v240, s[12:15], 0 offen offset:2048 lds
    s_add_u32 m0, s45, 48
    s_nop 0
    buffer_load_dwordx4 v240, s[12:15], 0 offen offset:3072 lds
    s_add_u32 m0, s45, 4160
    s_nop 0
    buffer_load_dwordx4 v240, s[12:15], s46 offen offset:0 lds
    s_add_u32 m0, s45, 4176
    s_nop 0
    buffer_load_dwordx4 v240, s[12:15], s46 offen offset:1024 lds
    s_add_u32 m0, s45, 4192
    s_nop 0
    buffer_load_dwordx4 v240, s[12:15], s46 offen offset:2048 lds
    s_add_u32 m0, s45, 4208
    s_nop 0
    buffer_load_dwordx4 v240, s[12:15], s46 offen offset:3072 lds
    v_add_u32 v241, s45, v241
    v_mov_b32 v0, 0
    v_mov_b32 v1, 0
    v_mov_b32 v2, 0
    v_mov_b32 v3, 0
    v_mov_b32 v4, 0
    v_mov_b32 v5, 0
    v_mov_b32 v6, 0
    v_mov_b32 v7, 0
    v_mov_b32 v8, 0
    v_mov_b32 v9, 0
    v_mov_b32 v10, 0
    v_mov_b32 v11, 0
    v_mov_b32 v12, 0
    v_mov_b32 v13, 0
    v_mov_b32 v14, 0
    v_mov_b32 v15, 0
    v_mov_b32 v16, 0
    v_mov_b32 v17, 0
    v_mov_b32 v18, 0
    v_mov_b32 v19, 0
    v_mov_b32 v20, 0
    v_mov_b32 v21, 0
    v_mov_b32 v22, 0
    v_mov_b32 v23, 0
    v_mov_b32 v24, 0
    v_mov_b32 v25, 0
    v_mov_b32 v26, 0
    v_mov_b32 v27, 0
    v_mov_b32 v28, 0
    v_mov_b32 v29, 0
    v_mov_b32 v30, 0
    v_mov_b32 v31, 0
    v_mov_b32 v32, 0
    v_mov_b32 v33, 0
    v_mov_b32 v34, 0
    v_mov_b32 v35, 0
    v_mov_b32 v36, 0
    v_mov_b32 v37, 0
    v_mov_b32 v38, 0
    v_mov_b32 v39, 0
    v_mov_b32 v40, 0
    v_mov_b32 v41, 0
    v_mov_b32 v42, 0
    v_mov_b32 v43, 0
    v_mov_b32 v44, 0
    v_mov_b32 v45, 0
    v_mov_b32 v46, 0
    v_mov_b32 v47, 0
    v_mov_b32 v48, 0
    v_mov_b32 v49, 0
    v_mov_b32 v50, 0
    v_mov_b32 v51, 0
    v_mov_b32 v52, 0
    v_mov_b32 v53, 0
    v_mov_b32 v54, 0
    v_mov_b32 v55, 0
    v_mov_b32 v56, 0
    v_mov_b32 v57, 0
    v_mov_b32 v58, 0
    v_mov_b32 v59, 0
    v_mov_b32 v60, 0
    v_mov_b32 v61, 0
    v_mov_b32 v62, 0
    v_mov_b32 v63, 0
    v_mov_b32 v144, 0
    v_mov_b32 v145, 0
    v_mov_b32 v146, 0
    v_mov_b32 v147, 0
    v_mov_b32 v148, 0
    v_mov_b32 v149, 0
    v_mov_b32 v150, 0
    v_mov_b32 v151, 0
    v_mov_b32 v152, 0
    v_mov_b32 v153, 0
    v_mov_b32 v154, 0
    v_mov_b32 v155, 0
    v_mov_b32 v156, 0
    v_mov_b32 v157, 0
    v_mov_b32 v158, 0
    v_mov_b32 v159, 0
    s_barrier
    ds_read_b128 v[160:163], v231 offset:0
    ds_read_b128 v[164:167], v231 offset:32
    ds_read_b128 v[168:171], v231 offset:64
    ds_read_b128 v[172:175], v231 offset:96
    ds_read_b128 v[176:179], v231 offset:128
    ds_read_b128 v[180:183], v231 offset:160
    ds_read_b128 v[184:187], v231 offset:192
    ds_read_b128 v[188:191], v231 offset:224
    ds_read_b128 v[192:195], v231 offset:512
    ds_read_b128 v[196:199], v231 offset:544
    ds_read_b128 v[200:203], v231 offset:576
    ds_read_b128 v[204:207], v231 offset:608
    ds_read_b128 v[208:211], v231 offset:640
    ds_read_b128 v[212:215], v231 offset:672
    ds_read_b128 v[216:219], v231 offset:704
    ds_read_b128 v[220:223], v231 offset:736
    s_waitcnt vmcnt(0)
L_wqJ:
    ds_read_b128 v[64:67], v241 offset:0
    ds_read_b128 v[68:71], v241 offset:32
    ds_read_b128 v[72:75], v241 offset:64
    ds_read_b128 v[76:79], v241 offset:96
    ds_read_b128 v[80:83], v241 offset:128
    ds_read_b128 v[84:87], v241 offset:160
    ds_read_b128 v[88:91], v241 offset:192
    ds_read_b128 v[92:95], v241 offset:224
    s_waitcnt lgkmcnt(0)
    s_mov_b32 s45, 0xffff0000
    v_lshlrev_b32 v238, 16, v64
    v_and_b32 v239, s45, v64
    v_mul_f32 v238, s42, v238
    v_mul_f32 v239, s42, v239
    v_cvt_pk_bf16_f32 v64, v238, v239
    v_lshlrev_b32 v238, 16, v65
    v_and_b32 v239, s45, v65
    v_mul_f32 v238, s42, v238
    v_mul_f32 v239, s42, v239
    v_cvt_pk_bf16_f32 v65, v238, v239
    v_lshlrev_b32 v238, 16, v66
    v_and_b32 v239, s45, v66
    v_mul_f32 v238, s42, v238
    v_mul_f32 v239, s42, v239
    v_cvt_pk_bf16_f32 v66, v238, v239
    v_lshlrev_b32 v238, 16, v67
    v_and_b32 v239, s45, v67
    v_mul_f32 v238, s42, v238
    v_mul_f32 v239, s42, v239
    v_cvt_pk_bf16_f32 v67, v238, v239
    v_lshlrev_b32 v238, 16, v68
    v_and_b32 v239, s45, v68
    v_mul_f32 v238, s42, v238
    v_mul_f32 v239, s42, v239
    v_cvt_pk_bf16_f32 v68, v238, v239
    v_lshlrev_b32 v238, 16, v69
    v_and_b32 v239, s45, v69
    v_mul_f32 v238, s42, v238
    v_mul_f32 v239, s42, v239
    v_cvt_pk_bf16_f32 v69, v238, v239
    v_lshlrev_b32 v238, 16, v70
    v_and_b32 v239, s45, v70
    v_mul_f32 v238, s42, v238
    v_mul_f32 v239, s42, v239
    v_cvt_pk_bf16_f32 v70, v238, v239
    v_lshlrev_b32 v238, 16, v71
    v_and_b32 v239, s45, v71
    v_mul_f32 v238, s42, v238
    v_mul_f32 v239, s42, v239
    v_cvt_pk_bf16_f32 v71, v238, v239
    v_lshlrev_b32 v238, 16, v72
    v_and_b32 v239, s45, v72
    v_mul_f32 v238, s42, v238
    v_mul_f32 v239, s42, v239
    v_cvt_pk_bf16_f32 v72, v238, v239
    v_lshlrev_b32 v238, 16, v73
    v_and_b32 v239, s45, v73
    v_mul_f32 v238, s42, v238
    v_mul_f32 v239, s42, v239
    v_cvt_pk_bf16_f32 v73, v238, v239
    v_lshlrev_b32 v238, 16, v74
    v_and_b32 v239, s45, v74
    v_mul_f32 v238, s42, v238
    v_mul_f32 v239, s42, v239
    v_cvt_pk_bf16_f32 v74, v238, v239
    v_lshlrev_b32 v238, 16, v75
    v_and_b32 v239, s45, v75
    v_mul_f32 v238, s42, v238
    v_mul_f32 v239, s42, v239
    v_cvt_pk_bf16_f32 v75, v238, v239
    v_lshlrev_b32 v238, 16, v76
    v_and_b32 v239, s45, v76
    v_mul_f32 v238, s42, v238
    v_mul_f32 v239, s42, v239
    v_cvt_pk_bf16_f32 v76, v238, v239
    v_lshlrev_b32 v238, 16, v77
    v_and_b32 v239, s45, v77
    v_mul_f32 v238, s42, v238
    v_mul_f32 v239, s42, v239
    v_cvt_pk_bf16_f32 v77, v238, v239
    v_lshlrev_b32 v238, 16, v78
    v_and_b32 v239, s45, v78
    v_mul_f32 v238, s42, v238
    v_mul_f32 v239, s42, v239
    v_cvt_pk_bf16_f32 v78, v238, v239
    v_lshlrev_b32 v238, 16, v79
    v_and_b32 v239, s45, v79
    v_mul_f32 v238, s42, v238
    v_mul_f32 v239, s42, v239
    v_cvt_pk_bf16_f32 v79, v238, v239
    v_lshlrev_b32 v238, 16, v80
    v_and_b32 v239, s45, v80
    v_mul_f32 v238, s42, v238
    v_mul_f32 v239, s42, v239
    v_cvt_pk_bf16_f32 v80, v238, v239
    v_lshlrev_b32 v238, 16, v81
    v_and_b32 v239, s45, v81
    v_mul_f32 v238, s42, v238
    v_mul_f32 v239, s42, v239
    v_cvt_pk_bf16_f32 v81, v238, v239
    v_lshlrev_b32 v238, 16, v82
    v_and_b32 v239, s45, v82
    v_mul_f32 v238, s42, v238
    v_mul_f32 v239, s42, v239
    v_cvt_pk_bf16_f32 v82, v238, v239
    v_lshlrev_b32 v238, 16, v83
    v_and_b32 v239, s45, v83
    v_mul_f32 v238, s42, v238
    v_mul_f32 v239, s42, v239
    v_cvt_pk_bf16_f32 v83, v238, v239
    v_lshlrev_b32 v238, 16, v84
    v_and_b32 v239, s45, v84
    v_mul_f32 v238, s42, v238
    v_mul_f32 v239, s42, v239
    v_cvt_pk_bf16_f32 v84, v238, v239
    v_lshlrev_b32 v238, 16, v85
    v_and_b32 v239, s45, v85
    v_mul_f32 v238, s42, v238
    v_mul_f32 v239, s42, v239
    v_cvt_pk_bf16_f32 v85, v238, v239
    v_lshlrev_b32 v238, 16, v86
    v_and_b32 v239, s45, v86
    v_mul_f32 v238, s42, v238
    v_mul_f32 v239, s42, v239
    v_cvt_pk_bf16_f32 v86, v238, v239
    v_lshlrev_b32 v238, 16, v87
    v_and_b32 v239, s45, v87
    v_mul_f32 v238, s42, v238
    v_mul_f32 v239, s42, v239
    v_cvt_pk_bf16_f32 v87, v238, v239
    v_lshlrev_b32 v238, 16, v88
    v_and_b32 v239, s45, v88
    v_mul_f32 v238, s42, v238
    v_mul_f32 v239, s42, v239
    v_cvt_pk_bf16_f32 v88, v238, v239
    v_lshlrev_b32 v238, 16, v89
    v_and_b32 v239, s45, v89
    v_mul_f32 v238, s42, v238
    v_mul_f32 v239, s42, v239
    v_cvt_pk_bf16_f32 v89, v238, v239
    v_lshlrev_b32 v238, 16, v90
    v_and_b32 v239, s45, v90
    v_mul_f32 v238, s42, v238
    v_mul_f32 v239, s42, v239
    v_cvt_pk_bf16_f32 v90, v238, v239
    v_lshlrev_b32 v238, 16, v91
    v_and_b32 v239, s45, v91
    v_mul_f32 v238, s42, v238
    v_mul_f32 v239, s42, v239
    v_cvt_pk_bf16_f32 v91, v238, v239
    v_lshlrev_b32 v238, 16, v92
    v_and_b32 v239, s45, v92
    v_mul_f32 v238, s42, v238
    v_mul_f32 v239, s42, v239
    v_cvt_pk_bf16_f32 v92, v238, v239
    v_lshlrev_b32 v238, 16, v93
    v_and_b32 v239, s45, v93
    v_mul_f32 v238, s42, v238
    v_mul_f32 v239, s42, v239
    v_cvt_pk_bf16_f32 v93, v238, v239
    v_lshlrev_b32 v238, 16, v94
    v_and_b32 v239, s45, v94
    v_mul_f32 v238, s42, v238
    v_mul_f32 v239, s42, v239
    v_cvt_pk_bf16_f32 v94, v238, v239
    v_lshlrev_b32 v238, 16, v95
    v_and_b32 v239, s45, v95
    v_mul_f32 v238, s42, v238
    v_mul_f32 v239, s42, v239
    v_cvt_pk_bf16_f32 v95, v238, v239
    s_waitcnt lgkmcnt(8)
    v_mfma_f32_32x32x16_bf16 v[96:111], v[160:163], v[64:67], v[144:159]
    v_mfma_f32_32x32x16_bf16 v[96:111], v[164:167], v[68:71], v[96:111]
    v_mfma_f32_32x32x16_bf16 v[96:111], v[168:171], v[72:75], v[96:111]
    v_mfma_f32_32x32x16_bf16 v[96:111], v[172:175], v[76:79], v[96:111]
    v_mfma_f32_32x32x16_bf16 v[96:111], v[176:179], v[80:83], v[96:111]
    v_mfma_f32_32x32x16_bf16 v[96:111], v[180:183], v[84:87], v[96:111]
    v_mfma_f32_32x32x16_bf16 v[96:111], v[184:187], v[88:91], v[96:111]
    v_mfma_f32_32x32x16_bf16 v[96:111], v[188:191], v[92:95], v[96:111]
    s_nop 7
    s_nop 7
    v_max3_f32 v238, v96, v97, v98
    v_max3_f32 v238, v238, v99, v100
    v_max3_f32 v238, v238, v101, v102
    v_max3_f32 v238, v238, v103, v104
    v_max3_f32 v238, v238, v105, v106
    v_max3_f32 v238, v238, v107, v108
    v_max3_f32 v238, v238, v109, v110
    v_max_f32 v238, v238, v111
    v_mov_b32 v239, v238
    s_nop 1
    v_permlane32_swap_b32 v238, v239
    s_nop 1
    v_max_f32 v238, v238, v239
    v_sub_f32 v144, 0, v238
    v_sub_f32 v145, 0, v238
    v_sub_f32 v146, 0, v238
    v_sub_f32 v147, 0, v238
    v_sub_f32 v148, 0, v238
    v_sub_f32 v149, 0, v238
    v_sub_f32 v150, 0, v238
    v_sub_f32 v151, 0, v238
    v_sub_f32 v152, 0, v238
    v_sub_f32 v153, 0, v238
    v_sub_f32 v154, 0, v238
    v_sub_f32 v155, 0, v238
    v_sub_f32 v156, 0, v238
    v_sub_f32 v157, 0, v238
    v_sub_f32 v158, 0, v238
    v_sub_f32 v159, 0, v238
    v_sub_f32 v96, v96, v238
    v_sub_f32 v97, v97, v238
    v_sub_f32 v98, v98, v238
    v_sub_f32 v99, v99, v238
    v_sub_f32 v100, v100, v238
    v_sub_f32 v101, v101, v238
    v_sub_f32 v102, v102, v238
    v_sub_f32 v103, v103, v238
    v_sub_f32 v104, v104, v238
    v_sub_f32 v105, v105, v238
    v_sub_f32 v106, v106, v238
    v_sub_f32 v107, v107, v238
    v_sub_f32 v108, v108, v238
    v_sub_f32 v109, v109, v238
    v_sub_f32 v110, v110, v238
    v_sub_f32 v111, v111, v238
    s_cmp_lg_u32 s31, 2
    s_cbranch_scc1 L_nomask1
    v_cmp_gt_i32 s[50:51], 0, v237
    v_cmp_gt_i32 s[52:53], 1, v237
    v_cmp_gt_i32 s[54:55], 2, v237
    v_cmp_gt_i32 s[56:57], 3, v237
    v_cmp_gt_i32 s[58:59], 8, v237
    v_cmp_gt_i32 s[60:61], 9, v237
    v_cmp_gt_i32 s[62:63], 10, v237
    v_cmp_gt_i32 s[64:65], 11, v237
    v_cmp_gt_i32 s[66:67], 16, v237
    v_cmp_gt_i32 s[68:69], 17, v237
    v_cmp_gt_i32 s[70:71], 18, v237
    v_cmp_gt_i32 s[72:73], 19, v237
    v_cmp_gt_i32 s[74:75], 24, v237
    v_cmp_gt_i32 s[76:77], 25, v237
    v_cmp_gt_i32 s[78:79], 26, v237
    v_cmp_gt_i32 s[80:81], 27, v237
    v_mov_b32 v238, s44
    s_nop 1
    v_cndmask_b32 v144, v144, v238, s[50:51]
    v_cndmask_b32 v145, v145, v238, s[52:53]
    v_cndmask_b32 v146, v146, v238, s[54:55]
    v_cndmask_b32 v147, v147, v238, s[56:57]
    v_cndmask_b32 v148, v148, v238, s[58:59]
    v_cndmask_b32 v149, v149, v238, s[60:61]
    v_cndmask_b32 v150, v150, v238, s[62:63]
    v_cndmask_b32 v151, v151, v238, s[64:65]
    v_cndmask_b32 v152, v152, v238, s[66:67]
    v_cndmask_b32 v153, v153, v238, s[68:69]
    v_cndmask_b32 v154, v154, v238, s[70:71]
    v_cndmask_b32 v155, v155, v238, s[72:73]
    v_cndmask_b32 v156, v156, v238, s[74:75]
    v_cndmask_b32 v157, v157, v238, s[76:77]
    v_cndmask_b32 v158, v158, v238, s[78:79]
    v_cndmask_b32 v159, v159, v238, s[80:81]
    s_nop 1
L_nomask1:
    s_waitcnt lgkmcnt(0)
    v_mfma_f32_32x32x16_bf16 v[112:127], v[192:195], v[64:67], v[144:159]
    v_mfma_f32_32x32x16_bf16 v[112:127], v[196:199], v[68:71], v[112:127]
    v_mfma_f32_32x32x16_bf16 v[112:127], v[200:203], v[72:75], v[112:127]
    v_mfma_f32_32x32x16_bf16 v[112:127], v[204:207], v[76:79], v[112:127]
    v_mfma_f32_32x32x16_bf16 v[112:127], v[208:211], v[80:83], v[112:127]
    v_mfma_f32_32x32x16_bf16 v[112:127], v[212:215], v[84:87], v[112:127]
    v_mfma_f32_32x32x16_bf16 v[112:127], v[216:219], v[88:91], v[112:127]
    v_mfma_f32_32x32x16_bf16 v[112:127], v[220:223], v[92:95], v[112:127]
    v_exp_f32 v224, v96
    v_exp_f32 v225, v97
    v_exp_f32 v226, v98
    v_add_f32 v228, v224, v225
    v_cvt_pk_bf16_f32 v128, v224, v225
    v_exp_f32 v227, v99
    v_exp_f32 v224, v100
    v_add_f32 v228, v228, v226
    v_add_f32 v228, v228, v227
    v_cvt_pk_bf16_f32 v129, v226, v227
    v_exp_f32 v225, v101
    v_exp_f32 v226, v102
    v_add_f32 v228, v228, v224
    v_add_f32 v228, v228, v225
    v_cvt_pk_bf16_f32 v130, v224, v225
    v_exp_f32 v227, v103
    v_exp_f32 v224, v104
    v_add_f32 v228, v228, v226
    v_add_f32 v228, v228, v227
    v_cvt_pk_bf16_f32 v131, v226, v227
    v_exp_f32 v225, v105
    v_exp_f32 v226, v106
    v_add_f32 v228, v228, v224
    v_add_f32 v228, v228, v225
    v_cvt_pk_bf16_f32 v132, v224, v225
    v_exp_f32 v227, v107
    v_exp_f32 v224, v108
    v_add_f32 v228, v228, v226
    v_add_f32 v228, v228, v227
    v_cvt_pk_bf16_f32 v133, v226, v227
    v_exp_f32 v225, v109
    v_exp_f32 v226, v110
    v_add_f32 v228, v228, v224
    v_add_f32 v228, v228, v225
    v_cvt_pk_bf16_f32 v134, v224, v225
    v_exp_f32 v227, v111
    v_add_f32 v228, v228, v226
    v_add_f32 v228, v228, v227
    v_cvt_pk_bf16_f32 v135, v226, v227
    v_mov_b32 v230, v228
    s_add_u32 s49, s49, 1
    s_and_b32 s49, s49, 3
    s_waitcnt vmcnt(8)
    s_barrier
    s_add_u32 s35, s35, 1
    s_cmp_eq_u32 s33, 0
    s_cbranch_scc1 L_nodma_1
    s_add_u32 s38, s49, 3
    s_and_b32 s38, s38, 3
    s_mul_i32 s38, s38, 16640
    s_xor_b32 s39, s49, 2
    s_mul_i32 s39, s39, 17408
    s_add_u32 s39, s39, 66560
    s_add_u32 m0, s38, s47
    s_nop 0
    buffer_load_dwordx4 v236, s[16:19], s36 offen offset:0 lds
    s_add_u32 m0, m0, 784
    s_nop 0
    buffer_load_dwordx4 v236, s[16:19], s36 offen offset:256 lds
    s_add_u32 m0, m0, 784
    s_nop 0
    buffer_load_dwordx4 v236, s[16:19], s36 offen offset:512 lds
    s_add_u32 m0, m0, 784
    s_nop 0
    buffer_load_dwordx4 v236, s[16:19], s36 offen offset:768 lds
    s_add_u32 s36, s36, 16384
    s_add_u32 m0, s39, s48
    s_nop 0
    buffer_load_dwordx4 v236, s[20:23], s37 offen offset:0 lds
    s_add_u32 m0, m0, 832
    s_nop 0
    buffer_load_dwordx4 v236, s[20:23], s37 offen offset:256 lds
    s_add_u32 m0, m0, 832
    s_nop 0
    buffer_load_dwordx4 v236, s[20:23], s37 offen offset:512 lds
    s_add_u32 m0, m0, 832
    s_nop 0
    buffer_load_dwordx4 v236, s[20:23], s37 offen offset:768 lds
    s_add_u32 s37, s37, 16384
L_nodma_1:
    s_add_u32 s40, s49, 1
    s_and_b32 s40, s40, 3
    s_mul_i32 s40, s40, 16640
    v_add_u32 v231, s40, v233
    s_mul_i32 s41, s49, 17408
    v_add_u32 v232, s41, v234
    ds_read_b128 v[160:163], v231 offset:0
    ds_read_b128 v[164:167], v231 offset:32
    ds_read_b128 v[168:171], v231 offset:64
    ds_read_b128 v[172:175], v231 offset:96
    ds_read_b128 v[176:179], v231 offset:128
    ds_read_b128 v[180:183], v231 offset:160
    ds_read_b128 v[184:187], v231 offset:192
    ds_read_b128 v[188:191], v231 offset:224
    ds_read_b64_tr_b16 v[192:193], v232 offset:0
    ds_read_b64_tr_b16 v[194:195], v232 offset:8704
    ds_read_b64_tr_b16 v[196:197], v232 offset:64
    ds_read_b64_tr_b16 v[198:199], v232 offset:8768
    ds_read_b64_tr_b16 v[200:201], v232 offset:128
    ds_read_b64_tr_b16 v[202:203], v232 offset:8832
    ds_read_b64_tr_b16 v[204:205], v232 offset:192
    ds_read_b64_tr_b16 v[206:207], v232 offset:8896
    v_exp_f32 v224, v112
    v_exp_f32 v225, v113
    v_exp_f32 v226, v114
    v_add_f32 v229, v224, v225
    v_cvt_pk_bf16_f32 v136, v224, v225
    v_exp_f32 v227, v115
    v_add_f32 v229, v229, v226
    v_add_f32 v229, v229, v227
    v_cvt_pk_bf16_f32 v137, v226, v227
    s_waitcnt lgkmcnt(0)
    s_sub_u32 s32, s31, 4
    s_cmp_eq_u32 s33, 0
    s_cbranch_scc1 L_loop0e_B
    s_cmp_eq_u32 s31, 1
    s_cbranch_scc1 L_tail2_0_A
    s_cmp_eq_u32 s31, 2
    s_cbranch_scc1 L_tail1_0e_A
    s_cmp_eq_u32 s31, 3
    s_cbranch_scc1 L_chain0e_A
    s_branch L_loop0e_A
.p2align 3
L_loop0_A:
    ds_read_b64_tr_b16 v[204:205], v232 offset:192
    ds_read_b64_tr_b16 v[206:207], v232 offset:8896
    buffer_load_dwordx4 v236, s[20:23], s37 offen offset:768 lds
    v_add_f32 v230, v230, v228
    v_cvt_pk_bf16_f32 v136, v224, v225
    v_exp_f32 v227, v115
    v_add_f32 v229, v229, v226
    v_add_f32 v229, v229, v227
    v_cvt_pk_bf16_f32 v137, v226, v227
    s_add_u32 s36, s36, 16384
    s_add_u32 s37, s37, 16384
L_loop0e_A:
    s_waitcnt lgkmcnt(8)
    v_mfma_f32_32x32x16_bf16 v[96:111], v[160:163], v[64:67], v[144:159]
    ds_read_b64_tr_b16 v[208:209], v232 offset:256
    v_exp_f32 v224, v116
    v_exp_f32 v225, v117
    v_mfma_f32_32x32x16_bf16 v[96:111], v[164:167], v[68:71], v[96:111]
    ds_read_b64_tr_b16 v[210:211], v232 offset:8960
    v_exp_f32 v226, v118
    v_add_f32 v229, v229, v224
    v_add_f32 v229, v229, v225
    v_cvt_pk_bf16_f32 v138, v224, v225
    v_mfma_f32_32x32x16_bf16 v[96:111], v[168:171], v[72:75], v[96:111]
    ds_read_b64_tr_b16 v[212:213], v232 offset:320
    v_exp_f32 v227, v119
    v_exp_f32 v224, v120
    v_add_f32 v229, v229, v226
    v_mfma_f32_32x32x16_bf16 v[96:111], v[172:175], v[76:79], v[96:111]
    ds_read_b64_tr_b16 v[214:215], v232 offset:9024
    v_add_f32 v229, v229, v227
    v_cvt_pk_bf16_f32 v139, v226, v227
    v_exp_f32 v225, v121
    v_mfma_f32_32x32x16_bf16 v[96:111], v[176:179], v[80:83], v[96:111]
    ds_read_b64_tr_b16 v[216:217], v232 offset:384
    v_exp_f32 v226, v122
    v_add_f32 v229, v229, v224
    v_add_f32 v229, v229, v225
    v_cvt_pk_bf16_f32 v140, v224, v225
    v_mfma_f32_32x32x16_bf16 v[96:111], v[180:183], v[84:87], v[96:111]
    ds_read_b64_tr_b16 v[218:219], v232 offset:9088
    v_exp_f32 v227, v123
    v_exp_f32 v224, v124
    v_add_f32 v229, v229, v226
    v_mfma_f32_32x32x16_bf16 v[96:111], v[184:187], v[88:91], v[96:111]
    ds_read_b64_tr_b16 v[220:221], v232 offset:448
    ds_read_b64_tr_b16 v[222:223], v232 offset:9152
    v_add_f32 v229, v229, v227
    v_cvt_pk_bf16_f32 v141, v226, v227
    v_exp_f32 v225, v125
    v_mfma_f32_32x32x16_bf16 v[96:111], v[188:191], v[92:95], v[96:111]
    v_exp_f32 v226, v126
    v_add_f32 v229, v229, v224
    v_add_f32 v229, v229, v225
    v_cvt_pk_bf16_f32 v142, v224, v225
    s_waitcnt lgkmcnt(0)
    v_mfma_f32_32x32x16_bf16 v[0:15], v[192:195], v[128:131], v[0:15]
    ds_read_b128 v[160:163], v231 offset:512
    ds_read_b128 v[164:167], v231 offset:544
    v_exp_f32 v227, v127
    v_add_f32 v229, v229, v226
    v_add_f32 v229, v229, v227
    v_mfma_f32_32x32x16_bf16 v[16:31], v[196:199], v[128:131], v[16:31]
    ds_read_b128 v[168:171], v231 offset:576
    ds_read_b128 v[172:175], v231 offset:608
    v_cvt_pk_bf16_f32 v143, v226, v227
    v_cmp_lt_f32 vcc, s43, v229
    v_mfma_f32_32x32x16_bf16 v[32:47], v[200:203], v[128:131], v[32:47]
    ds_read_b128 v[176:179], v231 offset:640
    ds_read_b128 v[180:183], v231 offset:672
    v_exp_f32 v224, v96
    v_exp_f32 v225, v97
    v_mfma_f32_32x32x16_bf16 v[48:63], v[204:207], v[128:131], v[48:63]
    ds_read_b128 v[184:187], v231 offset:704
    ds_read_b128 v[188:191], v231 offset:736
    v_exp_f32 v226, v98
    v_add_f32 v228, v224, v225
    v_cvt_pk_bf16_f32 v128, v224, v225
    v_mfma_f32_32x32x16_bf16 v[0:15], v[208:211], v[132:135], v[0:15]
    ds_read_b64_tr_b16 v[192:193], v232 offset:512
    ds_read_b64_tr_b16 v[194:195], v232 offset:9216
    v_exp_f32 v227, v99
    v_add_f32 v228, v228, v226
    v_add_f32 v228, v228, v227
    v_mfma_f32_32x32x16_bf16 v[16:31], v[212:215], v[132:135], v[16:31]
    ds_read_b64_tr_b16 v[196:197], v232 offset:576
    ds_read_b64_tr_b16 v[198:199], v232 offset:9280
    v_cvt_pk_bf16_f32 v129, v226, v227
    v_mfma_f32_32x32x16_bf16 v[32:47], v[216:219], v[132:135], v[32:47]
    ds_read_b64_tr_b16 v[200:201], v232 offset:640
    ds_read_b64_tr_b16 v[202:203], v232 offset:9344
    s_sub_u32 s32, s32, 1
    v_mfma_f32_32x32x16_bf16 v[48:63], v[220:223], v[132:135], v[48:63]
    s_cbranch_vccnz L_rare_1001
L_rareret_1002:
    s_cbranch_scc1 L_chain1_A
L_loop1_A:
    ds_read_b64_tr_b16 v[204:205], v232 offset:704
    ds_read_b64_tr_b16 v[206:207], v232 offset:9408
    v_add_f32 v230, v230, v229
    s_waitcnt lgkmcnt(8)
    v_mfma_f32_32x32x16_bf16 v[112:127], v[160:163], v[64:67], v[144:159]
    ds_read_b64_tr_b16 v[208:209], v232 offset:768
    v_exp_f32 v224, v100
    v_exp_f32 v225, v101
    v_exp_f32 v226, v102
    v_mfma_f32_32x32x16_bf16 v[112:127], v[164:167], v[68:71], v[112:127]
    ds_read_b64_tr_b16 v[210:211], v232 offset:9472
    s_add_u32 s49, s49, 1
    s_and_b32 s49, s49, 3
    v_add_f32 v228, v228, v224
    v_add_f32 v228, v228, v225
    v_cvt_pk_bf16_f32 v130, v224, v225
    s_add_u32 s38, s49, 3
    v_mfma_f32_32x32x16_bf16 v[112:127], v[168:171], v[72:75], v[112:127]
    ds_read_b64_tr_b16 v[212:213], v232 offset:832
    v_exp_f32 v227, v103
    v_exp_f32 v224, v104
    v_add_f32 v228, v228, v226
    v_add_f32 v228, v228, v227
    v_mfma_f32_32x32x16_bf16 v[112:127], v[172:175], v[76:79], v[112:127]
    ds_read_b64_tr_b16 v[214:215], v232 offset:9536
    v_cvt_pk_bf16_f32 v131, v226, v227
    v_exp_f32 v225, v105
    v_exp_f32 v226, v106
    v_add_f32 v228, v228, v224
    v_mfma_f32_32x32x16_bf16 v[112:127], v[176:179], v[80:83], v[112:127]
    ds_read_b64_tr_b16 v[216:217], v232 offset:896
    v_add_f32 v228, v228, v225
    v_cvt_pk_bf16_f32 v132, v224, v225
    v_exp_f32 v227, v107
    v_exp_f32 v224, v108
    v_mfma_f32_32x32x16_bf16 v[112:127], v[180:183], v[84:87], v[112:127]
    ds_read_b64_tr_b16 v[218:219], v232 offset:9600
    s_and_b32 s38, s38, 3
    s_mul_i32 s38, s38, 16640
    s_xor_b32 s39, s49, 2
    s_mul_i32 s39, s39, 17408
    s_add_u32 s39, s39, 66560
    v_add_f32 v228, v228, v226
    v_mfma_f32_32x32x16_bf16 v[112:127], v[184:187], v[88:91], v[112:127]
    ds_read_b64_tr_b16 v[220:221], v232 offset:960
    ds_read_b64_tr_b16 v[222:223], v232 offset:9664
    s_add_u32 s40, s49, 1
    s_and_b32 s40, s40, 3
    s_mul_i32 s40, s40, 16640
    v_add_u32 v231, s40, v233
    v_add_f32 v228, v228, v227
    v_mfma_f32_32x32x16_bf16 v[112:127], v[188:191], v[92:95], v[112:127]
    s_waitcnt vmcnt(8)
    s_barrier
    v_cvt_pk_bf16_f32 v133, v226, v227
    v_exp_f32 v225, v109
    s_add_u32 m0, s38, s47
    s_waitcnt lgkmcnt(0)
    v_mfma_f32_32x32x16_bf16 v[0:15], v[192:195], v[136:139], v[0:15]
    ds_read_b128 v[160:163], v231 offset:0
    ds_read_b128 v[164:167], v231 offset:32
    buffer_load_dwordx4 v236, s[16:19], s36 offen offset:0 lds
    v_exp_f32 v226, v110
    v_add_f32 v228, v228, v224
    s_add_u32 m0, m0, 784
    v_mfma_f32_32x32x16_bf16 v[16:31], v[196:199], v[136:139], v[16:31]
    ds_read_b128 v[168:171], v231 offset:64
    ds_read_b128 v[172:175], v231 offset:96
    buffer_load_dwordx4 v236, s[16:19], s36 offen offset:256 lds
    v_add_f32 v228, v228, v225
    v_cvt_pk_bf16_f32 v134, v224, v225
    s_mul_i32 s41, s49, 17408
    s_add_u32 m0, m0, 784
    v_mfma_f32_32x32x16_bf16 v[32:47], v[200:203], v[136:139], v[32:47]
    ds_read_b128 v[176:179], v231 offset:128
    ds_read_b128 v[180:183], v231 offset:160
    buffer_load_dwordx4 v236, s[16:19], s36 offen offset:512 lds
    v_add_u32 v232, s41, v234
    v_exp_f32 v227, v111
    s_add_u32 m0, m0, 784
    v_mfma_f32_32x32x16_bf16 v[48:63], v[204:207], v[136:139], v[48:63]
    ds_read_b128 v[184:187], v231 offset:192
    ds_read_b128 v[188:191], v231 offset:224
    buffer_load_dwordx4 v236, s[16:19], s36 offen offset:768 lds
    v_add_f32 v228, v228, v226
    v_add_f32 v228, v228, v227
    v_cvt_pk_bf16_f32 v135, v226, v227
    s_add_u32 m0, s39, s48
    v_mfma_f32_32x32x16_bf16 v[0:15], v[208:211], v[140:143], v[0:15]
    ds_read_b64_tr_b16 v[192:193], v232 offset:0
    ds_read_b64_tr_b16 v[194:195], v232 offset:8704
    buffer_load_dwordx4 v236, s[20:23], s37 offen offset:0 lds
    v_cmp_lt_f32 vcc, s43, v228
    v_exp_f32 v224, v112
    s_add_u32 m0, m0, 832
    v_mfma_f32_32x32x16_bf16 v[16:31], v[212:215], v[140:143], v[16:31]
    ds_read_b64_tr_b16 v[196:197], v232 offset:64
    ds_read_b64_tr_b16 v[198:199], v232 offset:8768
    buffer_load_dwordx4 v236, s[20:23], s37 offen offset:256 lds
    v_exp_f32 v225, v113
    s_add_u32 s35, s35, 1
    s_add_u32 m0, m0, 832
    v_mfma_f32_32x32x16_bf16 v[32:47], v[216:219], v[140:143], v[32:47]
    ds_read_b64_tr_b16 v[200:201], v232 offset:128
    ds_read_b64_tr_b16 v[202:203], v232 offset:8832
    buffer_load_dwordx4 v236, s[20:23], s37 offen offset:512 lds
    v_exp_f32 v226, v114
    v_add_f32 v229, v224, v225
    s_add_u32 m0, m0, 832
    s_sub_u32 s32, s32, 1
    v_mfma_f32_32x32x16_bf16 v[48:63], v[220:223], v[140:143], v[48:63]
    s_cbranch_vccnz L_rare_1004
L_rareret_1005:
    s_cbranch_scc0 L_loop0_A
L_chain0_A:
    ds_read_b64_tr_b16 v[204:205], v232 offset:192
    ds_read_b64_tr_b16 v[206:207], v232 offset:8896
    buffer_load_dwordx4 v236, s[20:23], s37 offen offset:768 lds
    v_add_f32 v230, v230, v228
    v_cvt_pk_bf16_f32 v136, v224, v225
    v_exp_f32 v227, v115
    v_add_f32 v229, v229, v226
    v_add_f32 v229, v229, v227
    v_cvt_pk_bf16_f32 v137, v226, v227
    s_add_u32 s36, s36, 16384
    s_add_u32 s37, s37, 16384
L_chain0e_A:
    v_cmp_gt_i32 s[50:51], 0, v237
    v_cmp_gt_i32 s[52:53], 1, v237
    v_cmp_gt_i32 s[54:55], 2, v237
    v_cmp_gt_i32 s[56:57], 3, v237
    v_cmp_gt_i32 s[58:59], 8, v237
    v_cmp_gt_i32 s[60:61], 9, v237
    v_cmp_gt_i32 s[62:63], 10, v237
    v_cmp_gt_i32 s[64:65], 11, v237
    v_cmp_gt_i32 s[66:67], 16, v237
    v_cmp_gt_i32 s[68:69], 17, v237
    v_cmp_gt_i32 s[70:71], 18, v237
    v_cmp_gt_i32 s[72:73], 19, v237
    v_cmp_gt_i32 s[74:75], 24, v237
    v_cmp_gt_i32 s[76:77], 25, v237
    v_cmp_gt_i32 s[78:79], 26, v237
    v_cmp_gt_i32 s[80:81], 27, v237
    v_mov_b32 v238, s44
    s_nop 1
    v_cndmask_b32 v144, v144, v238, s[50:51]
    v_cndmask_b32 v145, v145, v238, s[52:53]
    v_cndmask_b32 v146, v146, v238, s[54:55]
    v_cndmask_b32 v147, v147, v238, s[56:57]
    v_cndmask_b32 v148, v148, v238, s[58:59]
    v_cndmask_b32 v149, v149, v238, s[60:61]
    v_cndmask_b32 v150, v150, v238, s[62:63]
    v_cndmask_b32 v151, v151, v238, s[64:65]
    v_cndmask_b32 v152, v152, v238, s[66:67]
    v_cndmask_b32 v153, v153, v238, s[68:69]
    v_cndmask_b32 v154, v154, v238, s[70:71]
    v_cndmask_b32 v155, v155, v238, s[72:73]
    v_cndmask_b32 v156, v156, v238, s[74:75]
    v_cndmask_b32 v157, v157, v238, s[76:77]
    v_cndmask_b32 v158, v158, v238, s[78:79]
    v_cndmask_b32 v159, v159, v238, s[80:81]
    s_nop 1
    s_waitcnt lgkmcnt(8)
    v_mfma_f32_32x32x16_bf16 v[96:111], v[160:163], v[64:67], v[144:159]
    ds_read_b64_tr_b16 v[208:209], v232 offset:256
    v_exp_f32 v224, v116
    v_exp_f32 v225, v117
    v_mfma_f32_32x32x16_bf16 v[96:111], v[164:167], v[68:71], v[96:111]
    ds_read_b64_tr_b16 v[210:211], v232 offset:8960
    v_exp_f32 v226, v118
    v_add_f32 v229, v229, v224
    v_add_f32 v229, v229, v225
    v_cvt_pk_bf16_f32 v138, v224, v225
    v_mfma_f32_32x32x16_bf16 v[96:111], v[168:171], v[72:75], v[96:111]
    ds_read_b64_tr_b16 v[212:213], v232 offset:320
    v_exp_f32 v227, v119
    v_exp_f32 v224, v120
    v_add_f32 v229, v229, v226
    v_mfma_f32_32x32x16_bf16 v[96:111], v[172:175], v[76:79], v[96:111]
    ds_read_b64_tr_b16 v[214:215], v232 offset:9024
    v_add_f32 v229, v229, v227
    v_cvt_pk_bf16_f32 v139, v226, v227
    v_exp_f32 v225, v121
    v_mfma_f32_32x32x16_bf16 v[96:111], v[176:179], v[80:83], v[96:111]
    ds_read_b64_tr_b16 v[216:217], v232 offset:384
    v_exp_f32 v226, v122
    v_add_f32 v229, v229, v224
    v_add_f32 v229, v229, v225
    v_cvt_pk_bf16_f32 v140, v224, v225
    v_mfma_f32_32x32x16_bf16 v[96:111], v[180:183], v[84:87], v[96:111]
    ds_read_b64_tr_b16 v[218:219], v232 offset:9088
    v_exp_f32 v227, v123
    v_exp_f32 v224, v124
    v_add_f32 v229, v229, v226
    v_mfma_f32_32x32x16_bf16 v[96:111], v[184:187], v[88:91], v[96:111]
    ds_read_b64_tr_b16 v[220:221], v232 offset:448
    ds_read_b64_tr_b16 v[222:223], v232 offset:9152
    v_add_f32 v229, v229, v227
    v_cvt_pk_bf16_f32 v141, v226, v227
    v_exp_f32 v225, v125
    v_mfma_f32_32x32x16_bf16 v[96:111], v[188:191], v[92:95], v[96:111]
    v_exp_f32 v226, v126
    v_add_f32 v229, v229, v224
    v_add_f32 v229, v229, v225
    v_cvt_pk_bf16_f32 v142, v224, v225
    s_waitcnt lgkmcnt(0)
    v_mfma_f32_32x32x16_bf16 v[0:15], v[192:195], v[128:131], v[0:15]
    ds_read_b128 v[160:163], v231 offset:512
    ds_read_b128 v[164:167], v231 offset:544
    v_exp_f32 v227, v127
    v_add_f32 v229, v229, v226
    v_add_f32 v229, v229, v227
    v_mfma_f32_32x32x16_bf16 v[16:31], v[196:199], v[128:131], v[16:31]
    ds_read_b128 v[168:171], v231 offset:576
    ds_read_b128 v[172:175], v231 offset:608
    v_cvt_pk_bf16_f32 v143, v226, v227
    v_cmp_lt_f32 vcc, s43, v229
    v_mfma_f32_32x32x16_bf16 v[32:47], v[200:203], v[128:131], v[32:47]
    ds_read_b128 v[176:179], v231 offset:640
    ds_read_b128 v[180:183], v231 offset:672
    v_exp_f32 v224, v96
    v_exp_f32 v225, v97
    v_mfma_f32_32x32x16_bf16 v[48:63], v[204:207], v[128:131], v[48:63]
    ds_read_b128 v[184:187], v231 offset:704
    ds_read_b128 v[188:191], v231 offset:736
    v_exp_f32 v226, v98
    v_add_f32 v228, v224, v225
    v_cvt_pk_bf16_f32 v128, v224, v225
    v_mfma_f32_32x32x16_bf16 v[0:15], v[208:211], v[132:135], v[0:15]
    ds_read_b64_tr_b16 v[192:193], v232 offset:512
    ds_read_b64_tr_b16 v[194:195], v232 offset:9216
    v_exp_f32 v227, v99
    v_add_f32 v228, v228, v226
    v_add_f32 v228, v228, v227
    v_mfma_f32_32x32x16_bf16 v[16:31], v[212:215], v[132:135], v[16:31]
    ds_read_b64_tr_b16 v[196:197], v232 offset:576
    ds_read_b64_tr_b16 v[198:199], v232 offset:9280
    v_cvt_pk_bf16_f32 v129, v226, v227
    v_mfma_f32_32x32x16_bf16 v[32:47], v[216:219], v[132:135], v[32:47]
    ds_read_b64_tr_b16 v[200:201], v232 offset:640
    ds_read_b64_tr_b16 v[202:203], v232 offset:9344
    v_mfma_f32_32x32x16_bf16 v[48:63], v[220:223], v[132:135], v[48:63]
    s_cbranch_vccnz L_rare_1006
L_rareret_1007:
    ds_read_b64_tr_b16 v[204:205], v232 offset:704
    ds_read_b64_tr_b16 v[206:207], v232 offset:9408
    v_add_f32 v230, v230, v229
L_tail1_1e_A:
    ds_read_b64_tr_b16 v[208:209], v232 offset:768
    ds_read_b64_tr_b16 v[210:211], v232 offset:9472
    ds_read_b64_tr_b16 v[212:213], v232 offset:832
    ds_read_b64_tr_b16 v[214:215], v232 offset:9536
    ds_read_b64_tr_b16 v[216:217], v232 offset:896
    ds_read_b64_tr_b16 v[218:219], v232 offset:9600
    ds_read_b64_tr_b16 v[220:221], v232 offset:960
    ds_read_b64_tr_b16 v[222:223], v232 offset:9664
    s_add_u32 s49, s49, 1
    s_and_b32 s49, s49, 3
    s_waitcnt vmcnt(8)
    s_barrier
    s_add_u32 s35, s35, 1
    s_add_u32 s38, s49, 3
    s_and_b32 s38, s38, 3
    s_mul_i32 s38, s38, 16640
    s_xor_b32 s39, s49, 2
    s_mul_i32 s39, s39, 17408
    s_add_u32 s39, s39, 66560
    s_add_u32 m0, s38, s47
    s_nop 0
    buffer_load_dwordx4 v236, s[16:19], s36 offen offset:0 lds
    s_add_u32 m0, m0, 784
    s_nop 0
    buffer_load_dwordx4 v236, s[16:19], s36 offen offset:256 lds
    s_add_u32 m0, m0, 784
    s_nop 0
    buffer_load_dwordx4 v236, s[16:19], s36 offen offset:512 lds
    s_add_u32 m0, m0, 784
    s_nop 0
    buffer_load_dwordx4 v236, s[16:19], s36 offen offset:768 lds
    s_add_u32 s36, s36, 16384
    s_add_u32 m0, s39, s48
    s_nop 0
    buffer_load_dwordx4 v236, s[20:23], s37 offen offset:0 lds
    s_add_u32 m0, m0, 832
    s_nop 0
    buffer_load_dwordx4 v236, s[20:23], s37 offen offset:256 lds
    s_add_u32 m0, m0, 832
    s_nop 0
    buffer_load_dwordx4 v236, s[20:23], s37 offen offset:512 lds
    s_add_u32 m0, m0, 832
    s_nop 0
    buffer_load_dwordx4 v236, s[20:23], s37 offen offset:768 lds
    s_add_u32 s37, s37, 16384
    s_add_u32 s40, s49, 1
    s_and_b32 s40, s40, 3
    s_mul_i32 s40, s40, 16640
    v_add_u32 v231, s40, v233
    s_mul_i32 s41, s49, 17408
    v_add_u32 v232, s41, v234
    s_waitcnt lgkmcnt(8)
    v_mfma_f32_32x32x16_bf16 v[0:15], v[192:195], v[136:139], v[0:15]
    v_exp_f32 v224, v100
    v_exp_f32 v225, v101
    v_exp_f32 v226, v102
    v_add_f32 v228, v228, v224
    v_mfma_f32_32x32x16_bf16 v[16:31], v[196:199], v[136:139], v[16:31]
    v_add_f32 v228, v228, v225
    v_cvt_pk_bf16_f32 v130, v224, v225
    v_exp_f32 v227, v103
    v_exp_f32 v224, v104
    v_add_f32 v228, v228, v226
    v_mfma_f32_32x32x16_bf16 v[32:47], v[200:203], v[136:139], v[32:47]
    v_add_f32 v228, v228, v227
    v_cvt_pk_bf16_f32 v131, v226, v227
    v_exp_f32 v225, v105
    v_exp_f32 v226, v106
    v_add_f32 v228, v228, v224
    v_mfma_f32_32x32x16_bf16 v[48:63], v[204:207], v[136:139], v[48:63]
    v_add_f32 v228, v228, v225
    v_cvt_pk_bf16_f32 v132, v224, v225
    v_exp_f32 v227, v107
    v_exp_f32 v224, v108
    v_add_f32 v228, v228, v226
    s_waitcnt lgkmcnt(0)
    v_mfma_f32_32x32x16_bf16 v[0:15], v[208:211], v[140:143], v[0:15]
    ds_read_b64_tr_b16 v[192:193], v232 offset:0
    ds_read_b64_tr_b16 v[194:195], v232 offset:8704
    v_add_f32 v228, v228, v227
    v_cvt_pk_bf16_f32 v133, v226, v227
    v_exp_f32 v225, v109
    v_mfma_f32_32x32x16_bf16 v[16:31], v[212:215], v[140:143], v[16:31]
    ds_read_b64_tr_b16 v[196:197], v232 offset:64
    ds_read_b64_tr_b16 v[198:199], v232 offset:8768
    v_exp_f32 v226, v110
    v_add_f32 v228, v228, v224
    v_add_f32 v228, v228, v225
    v_cvt_pk_bf16_f32 v134, v224, v225
    v_mfma_f32_32x32x16_bf16 v[32:47], v[216:219], v[140:143], v[32:47]
    ds_read_b64_tr_b16 v[200:201], v232 offset:128
    ds_read_b64_tr_b16 v[202:203], v232 offset:8832
    v_exp_f32 v227, v111
    v_add_f32 v228, v228, v226
    v_add_f32 v228, v228, v227
    v_cvt_pk_bf16_f32 v135, v226, v227
    v_mfma_f32_32x32x16_bf16 v[48:63], v[220:223], v[140:143], v[48:63]
    ds_read_b64_tr_b16 v[204:205], v232 offset:192
    ds_read_b64_tr_b16 v[206:207], v232 offset:8896
    v_cmp_lt_f32 vcc, s43, v228
    s_cbranch_vccnz L_rare_1009
L_rareret_1010:
    v_add_f32 v230, v230, v228
L_tail2_0_A:
    ds_read_b64_tr_b16 v[208:209], v232 offset:256
    ds_read_b64_tr_b16 v[210:211], v232 offset:8960
    ds_read_b64_tr_b16 v[212:213], v232 offset:320
    ds_read_b64_tr_b16 v[214:215], v232 offset:9024
    ds_read_b64_tr_b16 v[216:217], v232 offset:384
    ds_read_b64_tr_b16 v[218:219], v232 offset:9088
    ds_read_b64_tr_b16 v[220:221], v232 offset:448
    ds_read_b64_tr_b16 v[222:223], v232 offset:9152
    s_waitcnt lgkmcnt(8)
    v_mfma_f32_32x32x16_bf16 v[0:15], v[192:195], v[128:131], v[0:15]
    v_mfma_f32_32x32x16_bf16 v[16:31], v[196:199], v[128:131], v[16:31]
    v_mfma_f32_32x32x16_bf16 v[32:47], v[200:203], v[128:131], v[32:47]
    v_mfma_f32_32x32x16_bf16 v[48:63], v[204:207], v[128:131], v[48:63]
    s_waitcnt lgkmcnt(0)
    v_mfma_f32_32x32x16_bf16 v[0:15], v[208:211], v[132:135], v[0:15]
    v_mfma_f32_32x32x16_bf16 v[16:31], v[212:215], v[132:135], v[16:31]
    v_mfma_f32_32x32x16_bf16 v[32:47], v[216:219], v[132:135], v[32:47]
    v_mfma_f32_32x32x16_bf16 v[48:63], v[220:223], v[132:135], v[48:63]
    s_branch L_epi
L_chain1_A:
    ds_read_b64_tr_b16 v[204:205], v232 offset:704
    ds_read_b64_tr_b16 v[206:207], v232 offset:9408
    v_add_f32 v230, v230, v229
L_chain1e_A:
    v_cmp_gt_i32 s[50:51], 0, v237
    v_cmp_gt_i32 s[52:53], 1, v237
    v_cmp_gt_i32 s[54:55], 2, v237
    v_cmp_gt_i32 s[56:57], 3, v237
    v_cmp_gt_i32 s[58:59], 8, v237
    v_cmp_gt_i32 s[60:61], 9, v237
    v_cmp_gt_i32 s[62:63], 10, v237
    v_cmp_gt_i32 s[64:65], 11, v237
    v_cmp_gt_i32 s[66:67], 16, v237
    v_cmp_gt_i32 s[68:69], 17, v237
    v_cmp_gt_i32 s[70:71], 18, v237
    v_cmp_gt_i32 s[72:73], 19, v237
    v_cmp_gt_i32 s[74:75], 24, v237
    v_cmp_gt_i32 s[76:77], 25, v237
    v_cmp_gt_i32 s[78:79], 26, v237
    v_cmp_gt_i32 s[80:81], 27, v237
    v_mov_b32 v238, s44
    s_nop 1
    v_cndmask_b32 v144, v144, v238, s[50:51]
    v_cndmask_b32 v145, v145, v238, s[52:53]
    v_cndmask_b32 v146, v146, v238, s[54:55]
    v_cndmask_b32 v147, v147, v238, s[56:57]
    v_cndmask_b32 v148, v148, v238, s[58:59]
    v_cndmask_b32 v149, v149, v238, s[60:61]
    v_cndmask_b32 v150, v150, v238, s[62:63]
    v_cndmask_b32 v151, v151, v238, s[64:65]
    v_cndmask_b32 v152, v152, v238, s[66:67]
    v_cndmask_b32 v153, v153, v238, s[68:69]
    v_cndmask_b32 v154, v154, v238, s[70:71]
    v_cndmask_b32 v155, v155, v238, s[72:73]
    v_cndmask_b32 v156, v156, v238, s[74:75]
    v_cndmask_b32 v157, v157, v238, s[76:77]
    v_cndmask_b32 v158, v158, v238, s[78:79]
    v_cndmask_b32 v159, v159, v238, s[80:81]
    s_nop 1
    s_waitcnt lgkmcnt(8)
    v_mfma_f32_32x32x16_bf16 v[112:127], v[160:163], v[64:67], v[144:159]
    ds_read_b64_tr_b16 v[208:209], v232 offset:768
    v_exp_f32 v224, v100
    v_exp_f32 v225, v101
    v_exp_f32 v226, v102
    v_mfma_f32_32x32x16_bf16 v[112:127], v[164:167], v[68:71], v[112:127]
    ds_read_b64_tr_b16 v[210:211], v232 offset:9472
    s_add_u32 s49, s49, 1
    s_and_b32 s49, s49, 3
    v_add_f32 v228, v228, v224
    v_add_f32 v228, v228, v225
    v_cvt_pk_bf16_f32 v130, v224, v225
    s_add_u32 s38, s49, 3
    v_mfma_f32_32x32x16_bf16 v[112:127], v[168:171], v[72:75], v[112:127]
    ds_read_b64_tr_b16 v[212:213], v232 offset:832
    v_exp_f32 v227, v103
    v_exp_f32 v224, v104
    v_add_f32 v228, v228, v226
    v_add_f32 v228, v228, v227
    v_mfma_f32_32x32x16_bf16 v[112:127], v[172:175], v[76:79], v[112:127]
    ds_read_b64_tr_b16 v[214:215], v232 offset:9536
    v_cvt_pk_bf16_f32 v131, v226, v227
    v_exp_f32 v225, v105
    v_exp_f32 v226, v106
    v_add_f32 v228, v228, v224
    v_mfma_f32_32x32x16_bf16 v[112:127], v[176:179], v[80:83], v[112:127]
    ds_read_b64_tr_b16 v[216:217], v232 offset:896
    v_add_f32 v228, v228, v225
    v_cvt_pk_bf16_f32 v132, v224, v225
    v_exp_f32 v227, v107
    v_exp_f32 v224, v108
    v_mfma_f32_32x32x16_bf16 v[112:127], v[180:183], v[84:87], v[112:127]
    ds_read_b64_tr_b16 v[218:219], v232 offset:9600
    s_and_b32 s38, s38, 3
    s_mul_i32 s38, s38, 16640
    s_xor_b32 s39, s49, 2
    s_mul_i32 s39, s39, 17408
    s_add_u32 s39, s39, 66560
    v_add_f32 v228, v228, v226
    v_mfma_f32_32x32x16_bf16 v[112:127], v[184:187], v[88:91], v[112:127]
    ds_read_b64_tr_b16 v[220:221], v232 offset:960
    ds_read_b64_tr_b16 v[222:223], v232 offset:9664
    s_add_u32 s40, s49, 1
    s_and_b32 s40, s40, 3
    s_mul_i32 s40, s40, 16640
    v_add_u32 v231, s40, v233
    v_add_f32 v228, v228, v227
    v_mfma_f32_32x32x16_bf16 v[112:127], v[188:191], v[92:95], v[112:127]
    s_waitcnt vmcnt(8)
    s_barrier
    v_cvt_pk_bf16_f32 v133, v226, v227
    v_exp_f32 v225, v109
    s_add_u32 m0, s38, s47
    s_waitcnt lgkmcnt(0)
    v_mfma_f32_32x32x16_bf16 v[0:15], v[192:195], v[136:139], v[0:15]
    ds_read_b128 v[160:163], v231 offset:0
    ds_read_b128 v[164:167], v231 offset:32
    buffer_load_dwordx4 v236, s[16:19], s36 offen offset:0 lds
    v_exp_f32 v226, v110
    v_add_f32 v228, v228, v224
    s_add_u32 m0, m0, 784
    v_mfma_f32_32x32x16_bf16 v[16:31], v[196:199], v[136:139], v[16:31]
    ds_read_b128 v[168:171], v231 offset:64
    ds_read_b128 v[172:175], v231 offset:96
    buffer_load_dwordx4 v236, s[16:19], s36 offen offset:256 lds
    v_add_f32 v228, v228, v225
    v_cvt_pk_bf16_f32 v134, v224, v225
    s_mul_i32 s41, s49, 17408
    s_add_u32 m0, m0, 784
    v_mfma_f32_32x32x16_bf16 v[32:47], v[200:203], v[136:139], v[32:47]
    ds_read_b128 v[176:179], v231 offset:128
    ds_read_b128 v[180:183], v231 offset:160
    buffer_load_dwordx4 v236, s[16:19], s36 offen offset:512 lds
    v_add_u32 v232, s41, v234
    v_exp_f32 v227, v111
    s_add_u32 m0, m0, 784
    v_mfma_f32_32x32x16_bf16 v[48:63], v[204:207], v[136:139], v[48:63]
    ds_read_b128 v[184:187], v231 offset:192
    ds_read_b128 v[188:191], v231 offset:224
    buffer_load_dwordx4 v236, s[16:19], s36 offen offset:768 lds
    v_add_f32 v228, v228, v226
    v_add_f32 v228, v228, v227
    v_cvt_pk_bf16_f32 v135, v226, v227
    s_add_u32 m0, s39, s48
    v_mfma_f32_32x32x16_bf16 v[0:15], v[208:211], v[140:143], v[0:15]
    ds_read_b64_tr_b16 v[192:193], v232 offset:0
    ds_read_b64_tr_b16 v[194:195], v232 offset:8704
    buffer_load_dwordx4 v236, s[20:23], s37 offen offset:0 lds
    v_cmp_lt_f32 vcc, s43, v228
    v_exp_f32 v224, v112
    s_add_u32 m0, m0, 832
    v_mfma_f32_32x32x16_bf16 v[16:31], v[212:215], v[140:143], v[16:31]
    ds_read_b64_tr_b16 v[196:197], v232 offset:64
    ds_read_b64_tr_b16 v[198:199], v232 offset:8768
    buffer_load_dwordx4 v236, s[20:23], s37 offen offset:256 lds
    v_exp_f32 v225, v113
    s_add_u32 s35, s35, 1
    s_add_u32 m0, m0, 832
    v_mfma_f32_32x32x16_bf16 v[32:47], v[216:219], v[140:143], v[32:47]
    ds_read_b64_tr_b16 v[200:201], v232 offset:128
    ds_read_b64_tr_b16 v[202:203], v232 offset:8832
    buffer_load_dwordx4 v236, s[20:23], s37 offen offset:512 lds
    v_exp_f32 v226, v114
    v_add_f32 v229, v224, v225
    s_add_u32 m0, m0, 832
    v_mfma_f32_32x32x16_bf16 v[48:63], v[220:223], v[140:143], v[48:63]
    s_cbranch_vccnz L_rare_1012
L_rareret_1013:
    ds_read_b64_tr_b16 v[204:205], v232 offset:192
    ds_read_b64_tr_b16 v[206:207], v232 offset:8896
    buffer_load_dwordx4 v236, s[20:23], s37 offen offset:768 lds
    v_add_f32 v230, v230, v228
    v_cvt_pk_bf16_f32 v136, v224, v225
    v_exp_f32 v227, v115
    v_add_f32 v229, v229, v226
    v_add_f32 v229, v229, v227
    v_cvt_pk_bf16_f32 v137, v226, v227
    s_add_u32 s36, s36, 16384
    s_add_u32 s37, s37, 16384
L_tail1_0e_A:
    ds_read_b64_tr_b16 v[208:209], v232 offset:256
    ds_read_b64_tr_b16 v[210:211], v232 offset:8960
    ds_read_b64_tr_b16 v[212:213], v232 offset:320
    ds_read_b64_tr_b16 v[214:215], v232 offset:9024
    ds_read_b64_tr_b16 v[216:217], v232 offset:384
    ds_read_b64_tr_b16 v[218:219], v232 offset:9088
    ds_read_b64_tr_b16 v[220:221], v232 offset:448
    ds_read_b64_tr_b16 v[222:223], v232 offset:9152
    s_waitcnt lgkmcnt(8)
    v_mfma_f32_32x32x16_bf16 v[0:15], v[192:195], v[128:131], v[0:15]
    v_exp_f32 v224, v116
    v_exp_f32 v225, v117
    v_exp_f32 v226, v118
    v_mfma_f32_32x32x16_bf16 v[16:31], v[196:199], v[128:131], v[16:31]
    v_add_f32 v229, v229, v224
    v_add_f32 v229, v229, v225
    v_cvt_pk_bf16_f32 v138, v224, v225
    v_exp_f32 v227, v119
    v_mfma_f32_32x32x16_bf16 v[32:47], v[200:203], v[128:131], v[32:47]
    v_exp_f32 v224, v120
    v_add_f32 v229, v229, v226
    v_add_f32 v229, v229, v227
    v_cvt_pk_bf16_f32 v139, v226, v227
    v_mfma_f32_32x32x16_bf16 v[48:63], v[204:207], v[128:131], v[48:63]
    v_exp_f32 v225, v121
    v_exp_f32 v226, v122
    v_add_f32 v229, v229, v224
    v_add_f32 v229, v229, v225
    s_waitcnt lgkmcnt(0)
    v_mfma_f32_32x32x16_bf16 v[0:15], v[208:211], v[132:135], v[0:15]
    ds_read_b64_tr_b16 v[192:193], v232 offset:512
    ds_read_b64_tr_b16 v[194:195], v232 offset:9216
    v_cvt_pk_bf16_f32 v140, v224, v225
    v_exp_f32 v227, v123
    v_mfma_f32_32x32x16_bf16 v[16:31], v[212:215], v[132:135], v[16:31]
    ds_read_b64_tr_b16 v[196:197], v232 offset:576
    ds_read_b64_tr_b16 v[198:199], v232 offset:9280
    v_exp_f32 v224, v124
    v_add_f32 v229, v229, v226
    v_add_f32 v229, v229, v227
    v_mfma_f32_32x32x16_bf16 v[32:47], v[216:219], v[132:135], v[32:47]
    ds_read_b64_tr_b16 v[200:201], v232 offset:640
    ds_read_b64_tr_b16 v[202:203], v232 offset:9344
    v_cvt_pk_bf16_f32 v141, v226, v227
    v_exp_f32 v225, v125
    v_mfma_f32_32x32x16_bf16 v[48:63], v[220:223], v[132:135], v[48:63]
    ds_read_b64_tr_b16 v[204:205], v232 offset:704
    ds_read_b64_tr_b16 v[206:207], v232 offset:9408
    v_exp_f32 v226, v126
    v_add_f32 v229, v229, v224
    v_add_f32 v229, v229, v225
    v_cvt_pk_bf16_f32 v142, v224, v225
    v_exp_f32 v227, v127
    v_add_f32 v229, v229, v226
    v_add_f32 v229, v229, v227
    v_cvt_pk_bf16_f32 v143, v226, v227
    v_cmp_lt_f32 vcc, s43, v229
    s_cbranch_vccnz L_rare_1014
L_rareret_1015:
    v_add_f32 v230, v230, v229
L_tail2_1_A:
    ds_read_b64_tr_b16 v[208:209], v232 offset:768
    ds_read_b64_tr_b16 v[210:211], v232 offset:9472
    ds_read_b64_tr_b16 v[212:213], v232 offset:832
    ds_read_b64_tr_b16 v[214:215], v232 offset:9536
    ds_read_b64_tr_b16 v[216:217], v232 offset:896
    ds_read_b64_tr_b16 v[218:219], v232 offset:9600
    ds_read_b64_tr_b16 v[220:221], v232 offset:960
    ds_read_b64_tr_b16 v[222:223], v232 offset:9664
    s_add_u32 s49, s49, 1
    s_and_b32 s49, s49, 3
    s_waitcnt vmcnt(8)
    s_barrier
    s_add_u32 s35, s35, 1
    s_add_u32 s38, s49, 3
    s_and_b32 s38, s38, 3
    s_mul_i32 s38, s38, 16640
    s_xor_b32 s39, s49, 2
    s_mul_i32 s39, s39, 17408
    s_add_u32 s39, s39, 66560
    s_add_u32 m0, s38, s47
    s_nop 0
    buffer_load_dwordx4 v236, s[16:19], s36 offen offset:0 lds
    s_add_u32 m0, m0, 784
    s_nop 0
    buffer_load_dwordx4 v236, s[16:19], s36 offen offset:256 lds
    s_add_u32 m0, m0, 784
    s_nop 0
    buffer_load_dwordx4 v236, s[16:19], s36 offen offset:512 lds
    s_add_u32 m0, m0, 784
    s_nop 0
    buffer_load_dwordx4 v236, s[16:19], s36 offen offset:768 lds
    s_add_u32 s36, s36, 16384
    s_add_u32 m0, s39, s48
    s_nop 0
    buffer_load_dwordx4 v236, s[20:23], s37 offen offset:0 lds
    s_add_u32 m0, m0, 832
    s_nop 0
    buffer_load_dwordx4 v236, s[20:23], s37 offen offset:256 lds
    s_add_u32 m0, m0, 832
    s_nop 0
    buffer_load_dwordx4 v236, s[20:23], s37 offen offset:512 lds
    s_add_u32 m0, m0, 832
    s_nop 0
    buffer_load_dwordx4 v236, s[20:23], s37 offen offset:768 lds
    s_add_u32 s37, s37, 16384
    s_add_u32 s40, s49, 1
    s_and_b32 s40, s40, 3
    s_mul_i32 s40, s40, 16640
    v_add_u32 v231, s40, v233
    s_mul_i32 s41, s49, 17408
    v_add_u32 v232, s41, v234
    s_waitcnt lgkmcnt(8)
    v_mfma_f32_32x32x16_bf16 v[0:15], v[192:195], v[136:139], v[0:15]
    v_mfma_f32_32x32x16_bf16 v[16:31], v[196:199], v[136:139], v[16:31]
    v_mfma_f32_32x32x16_bf16 v[32:47], v[200:203], v[136:139], v[32:47]
    v_mfma_f32_32x32x16_bf16 v[48:63], v[204:207], v[136:139], v[48:63]
    s_waitcnt lgkmcnt(0)
    v_mfma_f32_32x32x16_bf16 v[0:15], v[208:211], v[140:143], v[0:15]
    v_mfma_f32_32x32x16_bf16 v[16:31], v[212:215], v[140:143], v[16:31]
    v_mfma_f32_32x32x16_bf16 v[32:47], v[216:219], v[140:143], v[32:47]
    v_mfma_f32_32x32x16_bf16 v[48:63], v[220:223], v[140:143], v[48:63]
    s_branch L_epi
.p2align 3
L_loop0_B:
    ds_read_b64_tr_b16 v[204:205], v232 offset:192
    ds_read_b64_tr_b16 v[206:207], v232 offset:8896
    v_add_f32 v230, v230, v228
L_loop0e_B:
    s_waitcnt lgkmcnt(8)
    v_mfma_f32_32x32x16_bf16 v[96:111], v[160:163], v[64:67], v[144:159]
    ds_read_b64_tr_b16 v[208:209], v232 offset:256
    v_exp_f32 v224, v116
    v_exp_f32 v225, v117
    v_mfma_f32_32x32x16_bf16 v[96:111], v[164:167], v[68:71], v[96:111]
    ds_read_b64_tr_b16 v[210:211], v232 offset:8960
    v_exp_f32 v226, v118
    v_add_f32 v229, v229, v224
    v_add_f32 v229, v229, v225
    v_cvt_pk_bf16_f32 v138, v224, v225
    v_mfma_f32_32x32x16_bf16 v[96:111], v[168:171], v[72:75], v[96:111]
    ds_read_b64_tr_b16 v[212:213], v232 offset:320
    v_exp_f32 v227, v119
    v_exp_f32 v224, v120
    v_add_f32 v229, v229, v226
    v_mfma_f32_32x32x16_bf16 v[96:111], v[172:175], v[76:79], v[96:111]
    ds_read_b64_tr_b16 v[214:215], v232 offset:9024
    v_add_f32 v229, v229, v227
    v_cvt_pk_bf16_f32 v139, v226, v227
    v_exp_f32 v225, v121
    v_mfma_f32_32x32x16_bf16 v[96:111], v[176:179], v[80:83], v[96:111]
    ds_read_b64_tr_b16 v[216:217], v232 offset:384
    v_exp_f32 v226, v122
    v_add_f32 v229, v229, v224
    v_add_f32 v229, v229, v225
    v_cvt_pk_bf16_f32 v140, v224, v225
    v_mfma_f32_32x32x16_bf16 v[96:111], v[180:183], v[84:87], v[96:111]
    ds_read_b64_tr_b16 v[218:219], v232 offset:9088
    v_exp_f32 v227, v123
    v_exp_f32 v224, v124
    v_add_f32 v229, v229, v226
    v_mfma_f32_32x32x16_bf16 v[96:111], v[184:187], v[88:91], v[96:111]
    ds_read_b64_tr_b16 v[220:221], v232 offset:448
    ds_read_b64_tr_b16 v[222:223], v232 offset:9152
    v_add_f32 v229, v229, v227
    v_cvt_pk_bf16_f32 v141, v226, v227
    v_exp_f32 v225, v125
    v_mfma_f32_32x32x16_bf16 v[96:111], v[188:191], v[92:95], v[96:111]
    v_exp_f32 v226, v126
    v_add_f32 v229, v229, v224
    v_add_f32 v229, v229, v225
    v_cvt_pk_bf16_f32 v142, v224, v225
    s_waitcnt lgkmcnt(0)
    v_mfma_f32_32x32x16_bf16 v[0:15], v[192:195], v[128:131], v[0:15]
    ds_read_b128 v[160:163], v231 offset:512
    ds_read_b128 v[164:167], v231 offset:544
    v_exp_f32 v227, v127
    v_add_f32 v229, v229, v226
    v_add_f32 v229, v229, v227
    v_mfma_f32_32x32x16_bf16 v[16:31], v[196:199], v[128:131], v[16:31]
    ds_read_b128 v[168:171], v231 offset:576
    ds_read_b128 v[172:175], v231 offset:608
    v_cvt_pk_bf16_f32 v143, v226, v227
    v_cmp_lt_f32 vcc, s43, v229
    v_mfma_f32_32x32x16_bf16 v[32:47], v[200:203], v[128:131], v[32:47]
    ds_read_b128 v[176:179], v231 offset:640
    ds_read_b128 v[180:183], v231 offset:672
    v_exp_f32 v224, v96
    v_exp_f32 v225, v97
    v_mfma_f32_32x32x16_bf16 v[48:63], v[204:207], v[128:131], v[48:63]
    ds_read_b128 v[184:187], v231 offset:704
    ds_read_b128 v[188:191], v231 offset:736
    v_exp_f32 v226, v98
    v_add_f32 v228, v224, v225
    v_cvt_pk_bf16_f32 v128, v224, v225
    v_mfma_f32_32x32x16_bf16 v[0:15], v[208:211], v[132:135], v[0:15]
    ds_read_b64_tr_b16 v[192:193], v232 offset:512
    ds_read_b64_tr_b16 v[194:195], v232 offset:9216
    v_exp_f32 v227, v99
    v_add_f32 v228, v228, v226
    v_add_f32 v228, v228, v227
    v_mfma_f32_32x32x16_bf16 v[16:31], v[212:215], v[132:135], v[16:31]
    ds_read_b64_tr_b16 v[196:197], v232 offset:576
    ds_read_b64_tr_b16 v[198:199], v232 offset:9280
    v_cvt_pk_bf16_f32 v129, v226, v227
    v_mfma_f32_32x32x16_bf16 v[32:47], v[216:219], v[132:135], v[32:47]
    ds_read_b64_tr_b16 v[200:201], v232 offset:640
    ds_read_b64_tr_b16 v[202:203], v232 offset:9344
    s_sub_u32 s32, s32, 1
    v_mfma_f32_32x32x16_bf16 v[48:63], v[220:223], v[132:135], v[48:63]
    s_cbranch_vccnz L_rare_1017
L_rareret_1018:
    s_cbranch_scc1 L_chain1_B
L_loop1_B:
    ds_read_b64_tr_b16 v[204:205], v232 offset:704
    ds_read_b64_tr_b16 v[206:207], v232 offset:9408
    v_add_f32 v230, v230, v229
    s_waitcnt lgkmcnt(8)
    v_mfma_f32_32x32x16_bf16 v[112:127], v[160:163], v[64:67], v[144:159]
    ds_read_b64_tr_b16 v[208:209], v232 offset:768
    v_exp_f32 v224, v100
    v_exp_f32 v225, v101
    s_add_u32 s49, s49, 1
    v_mfma_f32_32x32x16_bf16 v[112:127], v[164:167], v[68:71], v[112:127]
    ds_read_b64_tr_b16 v[210:211], v232 offset:9472
    s_and_b32 s49, s49, 3
    v_exp_f32 v226, v102
    v_add_f32 v228, v228, v224
    v_add_f32 v228, v228, v225
    v_mfma_f32_32x32x16_bf16 v[112:127], v[168:171], v[72:75], v[112:127]
    ds_read_b64_tr_b16 v[212:213], v232 offset:832
    v_cvt_pk_bf16_f32 v130, v224, v225
    v_exp_f32 v227, v103
    v_exp_f32 v224, v104
    v_mfma_f32_32x32x16_bf16 v[112:127], v[172:175], v[76:79], v[112:127]
    ds_read_b64_tr_b16 v[214:215], v232 offset:9536
    v_add_f32 v228, v228, v226
    v_add_f32 v228, v228, v227
    v_cvt_pk_bf16_f32 v131, v226, v227
    v_exp_f32 v225, v105
    v_mfma_f32_32x32x16_bf16 v[112:127], v[176:179], v[80:83], v[112:127]
    ds_read_b64_tr_b16 v[216:217], v232 offset:896
    v_exp_f32 v226, v106
    v_add_f32 v228, v228, v224
    v_add_f32 v228, v228, v225
    v_cvt_pk_bf16_f32 v132, v224, v225
    v_mfma_f32_32x32x16_bf16 v[112:127], v[180:183], v[84:87], v[112:127]
    ds_read_b64_tr_b16 v[218:219], v232 offset:9600
    v_exp_f32 v227, v107
    v_exp_f32 v224, v108
    v_add_f32 v228, v228, v226
    v_mfma_f32_32x32x16_bf16 v[112:127], v[184:187], v[88:91], v[112:127]
    ds_read_b64_tr_b16 v[220:221], v232 offset:960
    ds_read_b64_tr_b16 v[222:223], v232 offset:9664
    s_add_u32 s40, s49, 1
    s_and_b32 s40, s40, 3
    s_mul_i32 s40, s40, 16640
    v_add_u32 v231, s40, v233
    v_mfma_f32_32x32x16_bf16 v[112:127], v[188:191], v[92:95], v[112:127]
    s_barrier
    v_add_f32 v228, v228, v227
    v_cvt_pk_bf16_f32 v133, v226, v227
    v_exp_f32 v225, v109
    s_waitcnt lgkmcnt(0)
    v_mfma_f32_32x32x16_bf16 v[0:15], v[192:195], v[136:139], v[0:15]
    ds_read_b128 v[160:163], v231 offset:0
    ds_read_b128 v[164:167], v231 offset:32
    v_exp_f32 v226, v110
    v_add_f32 v228, v228, v224
    v_add_f32 v228, v228, v225
    v_mfma_f32_32x32x16_bf16 v[16:31], v[196:199], v[136:139], v[16:31]
    ds_read_b128 v[168:171], v231 offset:64
    ds_read_b128 v[172:175], v231 offset:96
    v_cvt_pk_bf16_f32 v134, v224, v225
    v_exp_f32 v227, v111
    v_add_f32 v228, v228, v226
    v_mfma_f32_32x32x16_bf16 v[32:47], v[200:203], v[136:139], v[32:47]
    ds_read_b128 v[176:179], v231 offset:128
    ds_read_b128 v[180:183], v231 offset:160
    s_mul_i32 s41, s49, 17408
    v_add_u32 v232, s41, v234
    v_add_f32 v228, v228, v227
    v_cvt_pk_bf16_f32 v135, v226, v227
    v_mfma_f32_32x32x16_bf16 v[48:63], v[204:207], v[136:139], v[48:63]
    ds_read_b128 v[184:187], v231 offset:192
    ds_read_b128 v[188:191], v231 offset:224
    v_cmp_lt_f32 vcc, s43, v228
    v_exp_f32 v224, v112
    s_add_u32 s35, s35, 1
    v_mfma_f32_32x32x16_bf16 v[0:15], v[208:211], v[140:143], v[0:15]
    ds_read_b64_tr_b16 v[192:193], v232 offset:0
    ds_read_b64_tr_b16 v[194:195], v232 offset:8704
    v_exp_f32 v225, v113
    v_exp_f32 v226, v114
    v_mfma_f32_32x32x16_bf16 v[16:31], v[212:215], v[140:143], v[16:31]
    ds_read_b64_tr_b16 v[196:197], v232 offset:64
    ds_read_b64_tr_b16 v[198:199], v232 offset:8768
    v_add_f32 v229, v224, v225
    v_cvt_pk_bf16_f32 v136, v224, v225
    v_exp_f32 v227, v115
    v_mfma_f32_32x32x16_bf16 v[32:47], v[216:219], v[140:143], v[32:47]
    ds_read_b64_tr_b16 v[200:201], v232 offset:128
    ds_read_b64_tr_b16 v[202:203], v232 offset:8832
    v_add_f32 v229, v229, v226
    v_add_f32 v229, v229, v227
    v_cvt_pk_bf16_f32 v137, v226, v227
    s_sub_u32 s32, s32, 1
    v_mfma_f32_32x32x16_bf16 v[48:63], v[220:223], v[140:143], v[48:63]
    s_cbranch_vccnz L_rare_1020
L_rareret_1021:
    s_cbranch_scc0 L_loop0_B
L_chain0_B:
    ds_read_b64_tr_b16 v[204:205], v232 offset:192
    ds_read_b64_tr_b16 v[206:207], v232 offset:8896
    v_add_f32 v230, v230, v228
L_chain0e_B:
    v_cmp_gt_i32 s[50:51], 0, v237
    v_cmp_gt_i32 s[52:53], 1, v237
    v_cmp_gt_i32 s[54:55], 2, v237
    v_cmp_gt_i32 s[56:57], 3, v237
    v_cmp_gt_i32 s[58:59], 8, v237
    v_cmp_gt_i32 s[60:61], 9, v237
    v_cmp_gt_i32 s[62:63], 10, v237
    v_cmp_gt_i32 s[64:65], 11, v237
    v_cmp_gt_i32 s[66:67], 16, v237
    v_cmp_gt_i32 s[68:69], 17, v237
    v_cmp_gt_i32 s[70:71], 18, v237
    v_cmp_gt_i32 s[72:73], 19, v237
    v_cmp_gt_i32 s[74:75], 24, v237
    v_cmp_gt_i32 s[76:77], 25, v237
    v_cmp_gt_i32 s[78:79], 26, v237
    v_cmp_gt_i32 s[80:81], 27, v237
    v_mov_b32 v238, s44
    s_nop 1
    v_cndmask_b32 v144, v144, v238, s[50:51]
    v_cndmask_b32 v145, v145, v238, s[52:53]
    v_cndmask_b32 v146, v146, v238, s[54:55]
    v_cndmask_b32 v147, v147, v238, s[56:57]
    v_cndmask_b32 v148, v148, v238, s[58:59]
    v_cndmask_b32 v149, v149, v238, s[60:61]
    v_cndmask_b32 v150, v150, v238, s[62:63]
    v_cndmask_b32 v151, v151, v238, s[64:65]
    v_cndmask_b32 v152, v152, v238, s[66:67]
    v_cndmask_b32 v153, v153, v238, s[68:69]
    v_cndmask_b32 v154, v154, v238, s[70:71]
    v_cndmask_b32 v155, v155, v238, s[72:73]
    v_cndmask_b32 v156, v156, v238, s[74:75]
    v_cndmask_b32 v157, v157, v238, s[76:77]
    v_cndmask_b32 v158, v158, v238, s[78:79]
    v_cndmask_b32 v159, v159, v238, s[80:81]
    s_nop 1
    s_waitcnt lgkmcnt(8)
    v_mfma_f32_32x32x16_bf16 v[96:111], v[160:163], v[64:67], v[144:159]
    ds_read_b64_tr_b16 v[208:209], v232 offset:256
    v_exp_f32 v224, v116
    v_exp_f32 v225, v117
    v_mfma_f32_32x32x16_bf16 v[96:111], v[164:167], v[68:71], v[96:111]
    ds_read_b64_tr_b16 v[210:211], v232 offset:8960
    v_exp_f32 v226, v118
    v_add_f32 v229, v229, v224
    v_add_f32 v229, v229, v225
    v_cvt_pk_bf16_f32 v138, v224, v225
    v_mfma_f32_32x32x16_bf16 v[96:111], v[168:171], v[72:75], v[96:111]
    ds_read_b64_tr_b16 v[212:213], v232 offset:320
    v_exp_f32 v227, v119
    v_exp_f32 v224, v120
    v_add_f32 v229, v229, v226
    v_mfma_f32_32x32x16_bf16 v[96:111], v[172:175], v[76:79], v[96:111]
    ds_read_b64_tr_b16 v[214:215], v232 offset:9024
    v_add_f32 v229, v229, v227
    v_cvt_pk_bf16_f32 v139, v226, v227
    v_exp_f32 v225, v121
    v_mfma_f32_32x32x16_bf16 v[96:111], v[176:179], v[80:83], v[96:111]
    ds_read_b64_tr_b16 v[216:217], v232 offset:384
    v_exp_f32 v226, v122
    v_add_f32 v229, v229, v224
    v_add_f32 v229, v229, v225
    v_cvt_pk_bf16_f32 v140, v224, v225
    v_mfma_f32_32x32x16_bf16 v[96:111], v[180:183], v[84:87], v[96:111]
    ds_read_b64_tr_b16 v[218:219], v232 offset:9088
    v_exp_f32 v227, v123
    v_exp_f32 v224, v124
    v_add_f32 v229, v229, v226
    v_mfma_f32_32x32x16_bf16 v[96:111], v[184:187], v[88:91], v[96:111]
    ds_read_b64_tr_b16 v[220:221], v232 offset:448
    ds_read_b64_tr_b16 v[222:223], v232 offset:9152
    v_add_f32 v229, v229, v227
    v_cvt_pk_bf16_f32 v141, v226, v227
    v_exp_f32 v225, v125
    v_mfma_f32_32x32x16_bf16 v[96:111], v[188:191], v[92:95], v[96:111]
    v_exp_f32 v226, v126
    v_add_f32 v229, v229, v224
    v_add_f32 v229, v229, v225
    v_cvt_pk_bf16_f32 v142, v224, v225
    s_waitcnt lgkmcnt(0)
    v_mfma_f32_32x32x16_bf16 v[0:15], v[192:195], v[128:131], v[0:15]
    ds_read_b128 v[160:163], v231 offset:512
    ds_read_b128 v[164:167], v231 offset:544
    v_exp_f32 v227, v127
    v_add_f32 v229, v229, v226
    v_add_f32 v229, v229, v227
    v_mfma_f32_32x32x16_bf16 v[16:31], v[196:199], v[128:131], v[16:31]
    ds_read_b128 v[168:171], v231 offset:576
    ds_read_b128 v[172:175], v231 offset:608
    v_cvt_pk_bf16_f32 v143, v226, v227
    v_cmp_lt_f32 vcc, s43, v229
    v_mfma_f32_32x32x16_bf16 v[32:47], v[200:203], v[128:131], v[32:47]
    ds_read_b128 v[176:179], v231 offset:640
    ds_read_b128 v[180:183], v231 offset:672
    v_exp_f32 v224, v96
    v_exp_f32 v225, v97
    v_mfma_f32_32x32x16_bf16 v[48:63], v[204:207], v[128:131], v[48:63]
    ds_read_b128 v[184:187], v231 offset:704
    ds_read_b128 v[188:191], v231 offset:736
    v_exp_f32 v226, v98
    v_add_f32 v228, v224, v225
    v_cvt_pk_bf16_f32 v128, v224, v225
    v_mfma_f32_32x32x16_bf16 v[0:15], v[208:211], v[132:135], v[0:15]
    ds_read_b64_tr_b16 v[192:193], v232 offset:512
    ds_read_b64_tr_b16 v[194:195], v232 offset:9216
    v_exp_f32 v227, v99
    v_add_f32 v228, v228, v226
    v_add_f32 v228, v228, v227
    v_mfma_f32_32x32x16_bf16 v[16:31], v[212:215], v[132:135], v[16:31]
    ds_read_b64_tr_b16 v[196:197], v232 offset:576
    ds_read_b64_tr_b16 v[198:199], v232 offset:9280
    v_cvt_pk_bf16_f32 v129, v226, v227
    v_mfma_f32_32x32x16_bf16 v[32:47], v[216:219], v[132:135], v[32:47]
    ds_read_b64_tr_b16 v[200:201], v232 offset:640
    ds_read_b64_tr_b16 v[202:203], v232 offset:9344
    v_mfma_f32_32x32x16_bf16 v[48:63], v[220:223], v[132:135], v[48:63]
    s_cbranch_vccnz L_rare_1022
L_rareret_1023:
    ds_read_b64_tr_b16 v[204:205], v232 offset:704
    ds_read_b64_tr_b16 v[206:207], v232 offset:9408
    v_add_f32 v230, v230, v229
L_tail1_1e_B:
    ds_read_b64_tr_b16 v[208:209], v232 offset:768
    ds_read_b64_tr_b16 v[210:211], v232 offset:9472
    ds_read_b64_tr_b16 v[212:213], v232 offset:832
    ds_read_b64_tr_b16 v[214:215], v232 offset:9536
    ds_read_b64_tr_b16 v[216:217], v232 offset:896
    ds_read_b64_tr_b16 v[218:219], v232 offset:9600
    ds_read_b64_tr_b16 v[220:221], v232 offset:960
    ds_read_b64_tr_b16 v[222:223], v232 offset:9664
    s_add_u32 s49, s49, 1
    s_and_b32 s49, s49, 3
    s_cmp_ge_u32 s35, s34
    s_cbranch_scc1 L_skipbar_1024
    s_barrier
    s_add_u32 s35, s35, 1
L_skipbar_1024:
    s_add_u32 s40, s49, 1
    s_and_b32 s40, s40, 3
    s_mul_i32 s40, s40, 16640
    v_add_u32 v231, s40, v233
    s_mul_i32 s41, s49, 17408
    v_add_u32 v232, s41, v234
    s_waitcnt lgkmcnt(8)
    v_mfma_f32_32x32x16_bf16 v[0:15], v[192:195], v[136:139], v[0:15]
    v_exp_f32 v224, v100
    v_exp_f32 v225, v101
    v_exp_f32 v226, v102
    v_mfma_f32_32x32x16_bf16 v[16:31], v[196:199], v[136:139], v[16:31]
    v_add_f32 v228, v228, v224
    v_add_f32 v228, v228, v225
    v_cvt_pk_bf16_f32 v130, v224, v225
    v_exp_f32 v227, v103
    v_mfma_f32_32x32x16_bf16 v[32:47], v[200:203], v[136:139], v[32:47]
    v_exp_f32 v224, v104
    v_add_f32 v228, v228, v226
    v_add_f32 v228, v228, v227
    v_cvt_pk_bf16_f32 v131, v226, v227
    v_mfma_f32_32x32x16_bf16 v[48:63], v[204:207], v[136:139], v[48:63]
    v_exp_f32 v225, v105
    v_exp_f32 v226, v106
    v_add_f32 v228, v228, v224
    v_add_f32 v228, v228, v225
    s_waitcnt lgkmcnt(0)
    v_mfma_f32_32x32x16_bf16 v[0:15], v[208:211], v[140:143], v[0:15]
    ds_read_b64_tr_b16 v[192:193], v232 offset:0
    ds_read_b64_tr_b16 v[194:195], v232 offset:8704
    v_cvt_pk_bf16_f32 v132, v224, v225
    v_exp_f32 v227, v107
    v_mfma_f32_32x32x16_bf16 v[16:31], v[212:215], v[140:143], v[16:31]
    ds_read_b64_tr_b16 v[196:197], v232 offset:64
    ds_read_b64_tr_b16 v[198:199], v232 offset:8768
    v_exp_f32 v224, v108
    v_add_f32 v228, v228, v226
    v_add_f32 v228, v228, v227
    v_mfma_f32_32x32x16_bf16 v[32:47], v[216:219], v[140:143], v[32:47]
    ds_read_b64_tr_b16 v[200:201], v232 offset:128
    ds_read_b64_tr_b16 v[202:203], v232 offset:8832
    v_cvt_pk_bf16_f32 v133, v226, v227
    v_exp_f32 v225, v109
    v_mfma_f32_32x32x16_bf16 v[48:63], v[220:223], v[140:143], v[48:63]
    ds_read_b64_tr_b16 v[204:205], v232 offset:192
    ds_read_b64_tr_b16 v[206:207], v232 offset:8896
    v_exp_f32 v226, v110
    v_add_f32 v228, v228, v224
    v_add_f32 v228, v228, v225
    v_cvt_pk_bf16_f32 v134, v224, v225
    v_exp_f32 v227, v111
    v_add_f32 v228, v228, v226
    v_add_f32 v228, v228, v227
    v_cvt_pk_bf16_f32 v135, v226, v227
    v_cmp_lt_f32 vcc, s43, v228
    s_cbranch_vccnz L_rare_1025
L_rareret_1026:
    v_add_f32 v230, v230, v228
L_tail2_0_B:
    ds_read_b64_tr_b16 v[208:209], v232 offset:256
    ds_read_b64_tr_b16 v[210:211], v232 offset:8960
    ds_read_b64_tr_b16 v[212:213], v232 offset:320
    ds_read_b64_tr_b16 v[214:215], v232 offset:9024
    ds_read_b64_tr_b16 v[216:217], v232 offset:384
    ds_read_b64_tr_b16 v[218:219], v232 offset:9088
    ds_read_b64_tr_b16 v[220:221], v232 offset:448
    ds_read_b64_tr_b16 v[222:223], v232 offset:9152
    s_waitcnt lgkmcnt(8)
    v_mfma_f32_32x32x16_bf16 v[0:15], v[192:195], v[128:131], v[0:15]
    v_mfma_f32_32x32x16_bf16 v[16:31], v[196:199], v[128:131], v[16:31]
    v_mfma_f32_32x32x16_bf16 v[32:47], v[200:203], v[128:131], v[32:47]
    v_mfma_f32_32x32x16_bf16 v[48:63], v[204:207], v[128:131], v[48:63]
    s_waitcnt lgkmcnt(0)
    v_mfma_f32_32x32x16_bf16 v[0:15], v[208:211], v[132:135], v[0:15]
    v_mfma_f32_32x32x16_bf16 v[16:31], v[212:215], v[132:135], v[16:31]
    v_mfma_f32_32x32x16_bf16 v[32:47], v[216:219], v[132:135], v[32:47]
    v_mfma_f32_32x32x16_bf16 v[48:63], v[220:223], v[132:135], v[48:63]
    s_branch L_epi
L_chain1_B:
    ds_read_b64_tr_b16 v[204:205], v232 offset:704
    ds_read_b64_tr_b16 v[206:207], v232 offset:9408
    v_add_f32 v230, v230, v229
L_chain1e_B:
    v_cmp_gt_i32 s[50:51], 0, v237
    v_cmp_gt_i32 s[52:53], 1, v237
    v_cmp_gt_i32 s[54:55], 2, v237
    v_cmp_gt_i32 s[56:57], 3, v237
    v_cmp_gt_i32 s[58:59], 8, v237
    v_cmp_gt_i32 s[60:61], 9, v237
    v_cmp_gt_i32 s[62:63], 10, v237
    v_cmp_gt_i32 s[64:65], 11, v237
    v_cmp_gt_i32 s[66:67], 16, v237
    v_cmp_gt_i32 s[68:69], 17, v237
    v_cmp_gt_i32 s[70:71], 18, v237
    v_cmp_gt_i32 s[72:73], 19, v237
    v_cmp_gt_i32 s[74:75], 24, v237
    v_cmp_gt_i32 s[76:77], 25, v237
    v_cmp_gt_i32 s[78:79], 26, v237
    v_cmp_gt_i32 s[80:81], 27, v237
    v_mov_b32 v238, s44
    s_nop 1
    v_cndmask_b32 v144, v144, v238, s[50:51]
    v_cndmask_b32 v145, v145, v238, s[52:53]
    v_cndmask_b32 v146, v146, v238, s[54:55]
    v_cndmask_b32 v147, v147, v238, s[56:57]
    v_cndmask_b32 v148, v148, v238, s[58:59]
    v_cndmask_b32 v149, v149, v238, s[60:61]
    v_cndmask_b32 v150, v150, v238, s[62:63]
    v_cndmask_b32 v151, v151, v238, s[64:65]
    v_cndmask_b32 v152, v152, v238, s[66:67]
    v_cndmask_b32 v153, v153, v238, s[68:69]
    v_cndmask_b32 v154, v154, v238, s[70:71]
    v_cndmask_b32 v155, v155, v238, s[72:73]
    v_cndmask_b32 v156, v156, v238, s[74:75]
    v_cndmask_b32 v157, v157, v238, s[76:77]
    v_cndmask_b32 v158, v158, v238, s[78:79]
    v_cndmask_b32 v159, v159, v238, s[80:81]
    s_nop 1
    s_waitcnt lgkmcnt(8)
    v_mfma_f32_32x32x16_bf16 v[112:127], v[160:163], v[64:67], v[144:159]
    ds_read_b64_tr_b16 v[208:209], v232 offset:768
    v_exp_f32 v224, v100
    v_exp_f32 v225, v101
    s_add_u32 s49, s49, 1
    v_mfma_f32_32x32x16_bf16 v[112:127], v[164:167], v[68:71], v[112:127]
    ds_read_b64_tr_b16 v[210:211], v232 offset:9472
    s_and_b32 s49, s49, 3
    v_exp_f32 v226, v102
    v_add_f32 v228, v228, v224
    v_add_f32 v228, v228, v225
    v_mfma_f32_32x32x16_bf16 v[112:127], v[168:171], v[72:75], v[112:127]
    ds_read_b64_tr_b16 v[212:213], v232 offset:832
    v_cvt_pk_bf16_f32 v130, v224, v225
    v_exp_f32 v227, v103
    v_exp_f32 v224, v104
    v_mfma_f32_32x32x16_bf16 v[112:127], v[172:175], v[76:79], v[112:127]
    ds_read_b64_tr_b16 v[214:215], v232 offset:9536
    v_add_f32 v228, v228, v226
    v_add_f32 v228, v228, v227
    v_cvt_pk_bf16_f32 v131, v226, v227
    v_exp_f32 v225, v105
    v_mfma_f32_32x32x16_bf16 v[112:127], v[176:179], v[80:83], v[112:127]
    ds_read_b64_tr_b16 v[216:217], v232 offset:896
    v_exp_f32 v226, v106
    v_add_f32 v228, v228, v224
    v_add_f32 v228, v228, v225
    v_cvt_pk_bf16_f32 v132, v224, v225
    v_mfma_f32_32x32x16_bf16 v[112:127], v[180:183], v[84:87], v[112:127]
    ds_read_b64_tr_b16 v[218:219], v232 offset:9600
    v_exp_f32 v227, v107
    v_exp_f32 v224, v108
    v_add_f32 v228, v228, v226
    v_mfma_f32_32x32x16_bf16 v[112:127], v[184:187], v[88:91], v[112:127]
    ds_read_b64_tr_b16 v[220:221], v232 offset:960
    ds_read_b64_tr_b16 v[222:223], v232 offset:9664
    s_add_u32 s40, s49, 1
    s_and_b32 s40, s40, 3
    s_mul_i32 s40, s40, 16640
    v_add_u32 v231, s40, v233
    v_mfma_f32_32x32x16_bf16 v[112:127], v[188:191], v[92:95], v[112:127]
    s_cmp_ge_u32 s35, s34
    s_cbranch_scc1 L_skipbar_1027
    s_barrier
    s_add_u32 s35, s35, 1
L_skipbar_1027:
    v_add_f32 v228, v228, v227
    s_waitcnt lgkmcnt(0)
    v_mfma_f32_32x32x16_bf16 v[0:15], v[192:195], v[136:139], v[0:15]
    ds_read_b128 v[160:163], v231 offset:0
    ds_read_b128 v[164:167], v231 offset:32
    v_cvt_pk_bf16_f32 v133, v226, v227
    v_exp_f32 v225, v109
    s_mul_i32 s41, s49, 17408
    v_mfma_f32_32x32x16_bf16 v[16:31], v[196:199], v[136:139], v[16:31]
    ds_read_b128 v[168:171], v231 offset:64
    ds_read_b128 v[172:175], v231 offset:96
    v_exp_f32 v226, v110
    v_add_f32 v228, v228, v224
    v_add_f32 v228, v228, v225
    v_mfma_f32_32x32x16_bf16 v[32:47], v[200:203], v[136:139], v[32:47]
    ds_read_b128 v[176:179], v231 offset:128
    ds_read_b128 v[180:183], v231 offset:160
    v_add_u32 v232, s41, v234
    v_cvt_pk_bf16_f32 v134, v224, v225
    v_exp_f32 v227, v111
    v_mfma_f32_32x32x16_bf16 v[48:63], v[204:207], v[136:139], v[48:63]
    ds_read_b128 v[184:187], v231 offset:192
    ds_read_b128 v[188:191], v231 offset:224
    v_add_f32 v228, v228, v226
    v_add_f32 v228, v228, v227
    v_cvt_pk_bf16_f32 v135, v226, v227
    v_cmp_lt_f32 vcc, s43, v228
    v_mfma_f32_32x32x16_bf16 v[0:15], v[208:211], v[140:143], v[0:15]
    ds_read_b64_tr_b16 v[192:193], v232 offset:0
    ds_read_b64_tr_b16 v[194:195], v232 offset:8704
    v_exp_f32 v224, v112
    v_exp_f32 v225, v113
    v_mfma_f32_32x32x16_bf16 v[16:31], v[212:215], v[140:143], v[16:31]
    ds_read_b64_tr_b16 v[196:197], v232 offset:64
    ds_read_b64_tr_b16 v[198:199], v232 offset:8768
    v_exp_f32 v226, v114
    v_add_f32 v229, v224, v225
    v_cvt_pk_bf16_f32 v136, v224, v225
    v_mfma_f32_32x32x16_bf16 v[32:47], v[216:219], v[140:143], v[32:47]
    ds_read_b64_tr_b16 v[200:201], v232 offset:128
    ds_read_b64_tr_b16 v[202:203], v232 offset:8832
    v_exp_f32 v227, v115
    v_add_f32 v229, v229, v226
    v_add_f32 v229, v229, v227
    v_mfma_f32_32x32x16_bf16 v[48:63], v[220:223], v[140:143], v[48:63]
    s_cbranch_vccnz L_rare_1028
L_rareret_1029:
    ds_read_b64_tr_b16 v[204:205], v232 offset:192
    ds_read_b64_tr_b16 v[206:207], v232 offset:8896
    v_add_f32 v230, v230, v228
    v_cvt_pk_bf16_f32 v137, v226, v227
L_tail1_0e_B:
    ds_read_b64_tr_b16 v[208:209], v232 offset:256
    ds_read_b64_tr_b16 v[210:211], v232 offset:8960
    ds_read_b64_tr_b16 v[212:213], v232 offset:320
    ds_read_b64_tr_b16 v[214:215], v232 offset:9024
    ds_read_b64_tr_b16 v[216:217], v232 offset:384
    ds_read_b64_tr_b16 v[218:219], v232 offset:9088
    ds_read_b64_tr_b16 v[220:221], v232 offset:448
    ds_read_b64_tr_b16 v[222:223], v232 offset:9152
    s_waitcnt lgkmcnt(8)
    v_mfma_f32_32x32x16_bf16 v[0:15], v[192:195], v[128:131], v[0:15]
    v_exp_f32 v224, v116
    v_exp_f32 v225, v117
    v_exp_f32 v226, v118
    v_mfma_f32_32x32x16_bf16 v[16:31], v[196:199], v[128:131], v[16:31]
    v_add_f32 v229, v229, v224
    v_add_f32 v229, v229, v225
    v_cvt_pk_bf16_f32 v138, v224, v225
    v_exp_f32 v227, v119
    v_mfma_f32_32x32x16_bf16 v[32:47], v[200:203], v[128:131], v[32:47]
    v_exp_f32 v224, v120
    v_add_f32 v229, v229, v226
    v_add_f32 v229, v229, v227
    v_cvt_pk_bf16_f32 v139, v226, v227
    v_mfma_f32_32x32x16_bf16 v[48:63], v[204:207], v[128:131], v[48:63]
    v_exp_f32 v225, v121
    v_exp_f32 v226, v122
    v_add_f32 v229, v229, v224
    v_add_f32 v229, v229, v225
    s_waitcnt lgkmcnt(0)
    v_mfma_f32_32x32x16_bf16 v[0:15], v[208:211], v[132:135], v[0:15]
    ds_read_b64_tr_b16 v[192:193], v232 offset:512
    ds_read_b64_tr_b16 v[194:195], v232 offset:9216
    v_cvt_pk_bf16_f32 v140, v224, v225
    v_exp_f32 v227, v123
    v_mfma_f32_32x32x16_bf16 v[16:31], v[212:215], v[132:135], v[16:31]
    ds_read_b64_tr_b16 v[196:197], v232 offset:576
    ds_read_b64_tr_b16 v[198:199], v232 offset:9280
    v_exp_f32 v224, v124
    v_add_f32 v229, v229, v226
    v_add_f32 v229, v229, v227
    v_mfma_f32_32x32x16_bf16 v[32:47], v[216:219], v[132:135], v[32:47]
    ds_read_b64_tr_b16 v[200:201], v232 offset:640
    ds_read_b64_tr_b16 v[202:203], v232 offset:9344
    v_cvt_pk_bf16_f32 v141, v226, v227
    v_exp_f32 v225, v125
    v_mfma_f32_32x32x16_bf16 v[48:63], v[220:223], v[132:135], v[48:63]
    ds_read_b64_tr_b16 v[204:205], v232 offset:704
    ds_read_b64_tr_b16 v[206:207], v232 offset:9408
    v_exp_f32 v226, v126
    v_add_f32 v229, v229, v224
    v_add_f32 v229, v229, v225
    v_cvt_pk_bf16_f32 v142, v224, v225
    v_exp_f32 v227, v127
    v_add_f32 v229, v229, v226
    v_add_f32 v229, v229, v227
    v_cvt_pk_bf16_f32 v143, v226, v227
    v_cmp_lt_f32 vcc, s43, v229
    s_cbranch_vccnz L_rare_1030
L_rareret_1031:
    v_add_f32 v230, v230, v229
L_tail2_1_B:
    ds_read_b64_tr_b16 v[208:209], v232 offset:768
    ds_read_b64_tr_b16 v[210:211], v232 offset:9472
    ds_read_b64_tr_b16 v[212:213], v232 offset:832
    ds_read_b64_tr_b16 v[214:215], v232 offset:9536
    ds_read_b64_tr_b16 v[216:217], v232 offset:896
    ds_read_b64_tr_b16 v[218:219], v232 offset:9600
    ds_read_b64_tr_b16 v[220:221], v232 offset:960
    ds_read_b64_tr_b16 v[222:223], v232 offset:9664
    s_add_u32 s49, s49, 1
    s_and_b32 s49, s49, 3
    s_cmp_ge_u32 s35, s34
    s_cbranch_scc1 L_skipbar_1032
    s_barrier
    s_add_u32 s35, s35, 1
L_skipbar_1032:
    s_add_u32 s40, s49, 1
    s_and_b32 s40, s40, 3
    s_mul_i32 s40, s40, 16640
    v_add_u32 v231, s40, v233
    s_mul_i32 s41, s49, 17408
    v_add_u32 v232, s41, v234
    s_waitcnt lgkmcnt(8)
    v_mfma_f32_32x32x16_bf16 v[0:15], v[192:195], v[136:139], v[0:15]
    v_mfma_f32_32x32x16_bf16 v[16:31], v[196:199], v[136:139], v[16:31]
    v_mfma_f32_32x32x16_bf16 v[32:47], v[200:203], v[136:139], v[32:47]
    v_mfma_f32_32x32x16_bf16 v[48:63], v[204:207], v[136:139], v[48:63]
    s_waitcnt lgkmcnt(0)
    v_mfma_f32_32x32x16_bf16 v[0:15], v[208:211], v[140:143], v[0:15]
    v_mfma_f32_32x32x16_bf16 v[16:31], v[212:215], v[140:143], v[16:31]
    v_mfma_f32_32x32x16_bf16 v[32:47], v[216:219], v[140:143], v[32:47]
    v_mfma_f32_32x32x16_bf16 v[48:63], v[220:223], v[140:143], v[48:63]
L_epi:
    s_cmp_lg_u32 s33, 0
    s_cbranch_scc1 L_epi2
L_bbar:
    s_cmp_ge_u32 s35, s34
    s_cbranch_scc1 L_epi2
    s_barrier
    s_add_u32 s35, s35, 1
    s_branch L_bbar
L_epi2:
    v_mov_b32 v238, v230
    s_nop 7
    v_permlane32_swap_b32 v238, v230
    s_nop 7
    v_add_f32 v230, v230, v238
    v_rcp_f32 v239, v230
    s_nop 1
    v_mul_f32 v0, v0, v239
    v_mul_f32 v1, v1, v239
    v_mul_f32 v2, v2, v239
    v_mul_f32 v3, v3, v239
    v_mul_f32 v4, v4, v239
    v_mul_f32 v5, v5, v239
    v_mul_f32 v6, v6, v239
    v_mul_f32 v7, v7, v239
    v_cvt_pk_bf16_f32 v160, v0, v1
    v_cvt_pk_bf16_f32 v161, v2, v3
    v_cvt_pk_bf16_f32 v162, v4, v5
    v_cvt_pk_bf16_f32 v163, v6, v7
    s_nop 1
    v_permlane32_swap_b32 v160, v162
    v_permlane32_swap_b32 v161, v163
    s_nop 1
    buffer_store_dwordx4 v[160:163], v235, s[24:27], 0 offen offset:0
    v_mul_f32 v8, v8, v239
    v_mul_f32 v9, v9, v239
    v_mul_f32 v10, v10, v239
    v_mul_f32 v11, v11, v239
    v_mul_f32 v12, v12, v239
    v_mul_f32 v13, v13, v239
    v_mul_f32 v14, v14, v239
    v_mul_f32 v15, v15, v239
    v_cvt_pk_bf16_f32 v164, v8, v9
    v_cvt_pk_bf16_f32 v165, v10, v11
    v_cvt_pk_bf16_f32 v166, v12, v13
    v_cvt_pk_bf16_f32 v167, v14, v15
    s_nop 1
    v_permlane32_swap_b32 v164, v166
    v_permlane32_swap_b32 v165, v167
    s_nop 1
    buffer_store_dwordx4 v[164:167], v235, s[24:27], 0 offen offset:32
    v_mul_f32 v16, v16, v239
    v_mul_f32 v17, v17, v239
    v_mul_f32 v18, v18, v239
    v_mul_f32 v19, v19, v239
    v_mul_f32 v20, v20, v239
    v_mul_f32 v21, v21, v239
    v_mul_f32 v22, v22, v239
    v_mul_f32 v23, v23, v239
    v_cvt_pk_bf16_f32 v168, v16, v17
    v_cvt_pk_bf16_f32 v169, v18, v19
    v_cvt_pk_bf16_f32 v170, v20, v21
    v_cvt_pk_bf16_f32 v171, v22, v23
    s_nop 1
    v_permlane32_swap_b32 v168, v170
    v_permlane32_swap_b32 v169, v171
    s_nop 1
    buffer_store_dwordx4 v[168:171], v235, s[24:27], 0 offen offset:64
    v_mul_f32 v24, v24, v239
    v_mul_f32 v25, v25, v239
    v_mul_f32 v26, v26, v239
    v_mul_f32 v27, v27, v239
    v_mul_f32 v28, v28, v239
    v_mul_f32 v29, v29, v239
    v_mul_f32 v30, v30, v239
    v_mul_f32 v31, v31, v239
    v_cvt_pk_bf16_f32 v172, v24, v25
    v_cvt_pk_bf16_f32 v173, v26, v27
    v_cvt_pk_bf16_f32 v174, v28, v29
    v_cvt_pk_bf16_f32 v175, v30, v31
    s_nop 1
    v_permlane32_swap_b32 v172, v174
    v_permlane32_swap_b32 v173, v175
    s_nop 1
    buffer_store_dwordx4 v[172:175], v235, s[24:27], 0 offen offset:96
    v_mul_f32 v32, v32, v239
    v_mul_f32 v33, v33, v239
    v_mul_f32 v34, v34, v239
    v_mul_f32 v35, v35, v239
    v_mul_f32 v36, v36, v239
    v_mul_f32 v37, v37, v239
    v_mul_f32 v38, v38, v239
    v_mul_f32 v39, v39, v239
    v_cvt_pk_bf16_f32 v176, v32, v33
    v_cvt_pk_bf16_f32 v177, v34, v35
    v_cvt_pk_bf16_f32 v178, v36, v37
    v_cvt_pk_bf16_f32 v179, v38, v39
    s_nop 1
    v_permlane32_swap_b32 v176, v178
    v_permlane32_swap_b32 v177, v179
    s_nop 1
    buffer_store_dwordx4 v[176:179], v235, s[24:27], 0 offen offset:128
    v_mul_f32 v40, v40, v239
    v_mul_f32 v41, v41, v239
    v_mul_f32 v42, v42, v239
    v_mul_f32 v43, v43, v239
    v_mul_f32 v44, v44, v239
    v_mul_f32 v45, v45, v239
    v_mul_f32 v46, v46, v239
    v_mul_f32 v47, v47, v239
    v_cvt_pk_bf16_f32 v180, v40, v41
    v_cvt_pk_bf16_f32 v181, v42, v43
    v_cvt_pk_bf16_f32 v182, v44, v45
    v_cvt_pk_bf16_f32 v183, v46, v47
    s_nop 1
    v_permlane32_swap_b32 v180, v182
    v_permlane32_swap_b32 v181, v183
    s_nop 1
    buffer_store_dwordx4 v[180:183], v235, s[24:27], 0 offen offset:160
    v_mul_f32 v48, v48, v239
    v_mul_f32 v49, v49, v239
    v_mul_f32 v50, v50, v239
    v_mul_f32 v51, v51, v239
    v_mul_f32 v52, v52, v239
    v_mul_f32 v53, v53, v239
    v_mul_f32 v54, v54, v239
    v_mul_f32 v55, v55, v239
    v_cvt_pk_bf16_f32 v184, v48, v49
    v_cvt_pk_bf16_f32 v185, v50, v51
    v_cvt_pk_bf16_f32 v186, v52, v53
    v_cvt_pk_bf16_f32 v187, v54, v55
    s_nop 1
    v_permlane32_swap_b32 v184, v186
    v_permlane32_swap_b32 v185, v187
    s_nop 1
    buffer_store_dwordx4 v[184:187], v235, s[24:27], 0 offen offset:192
    v_mul_f32 v56, v56, v239
    v_mul_f32 v57, v57, v239
    v_mul_f32 v58, v58, v239
    v_mul_f32 v59, v59, v239
    v_mul_f32 v60, v60, v239
    v_mul_f32 v61, v61, v239
    v_mul_f32 v62, v62, v239
    v_mul_f32 v63, v63, v239
    v_cvt_pk_bf16_f32 v188, v56, v57
    v_cvt_pk_bf16_f32 v189, v58, v59
    v_cvt_pk_bf16_f32 v190, v60, v61
    v_cvt_pk_bf16_f32 v191, v62, v63
    s_nop 1
    v_permlane32_swap_b32 v188, v190
    v_permlane32_swap_b32 v189, v191
    s_nop 1
    buffer_store_dwordx4 v[188:191], v235, s[24:27], 0 offen offset:224
    s_cmp_eq_u32 s33, 0
    s_cbranch_scc1 L_loadend
L_load:
    s_cmp_ge_u32 s35, s34
    s_cbranch_scc1 L_loadend
    s_waitcnt vmcnt(8)
    s_barrier
    s_add_u32 s35, s35, 1
    s_add_u32 s49, s49, 1
    s_and_b32 s49, s49, 3
    s_add_u32 s38, s49, 3
    s_and_b32 s38, s38, 3
    s_mul_i32 s38, s38, 16640
    s_xor_b32 s39, s49, 2
    s_mul_i32 s39, s39, 17408
    s_add_u32 s39, s39, 66560
    s_add_u32 m0, s38, s47
    s_nop 0
    buffer_load_dwordx4 v236, s[16:19], s36 offen offset:0 lds
    s_add_u32 m0, m0, 784
    s_nop 0
    buffer_load_dwordx4 v236, s[16:19], s36 offen offset:256 lds
    s_add_u32 m0, m0, 784
    s_nop 0
    buffer_load_dwordx4 v236, s[16:19], s36 offen offset:512 lds
    s_add_u32 m0, m0, 784
    s_nop 0
    buffer_load_dwordx4 v236, s[16:19], s36 offen offset:768 lds
    s_add_u32 s36, s36, 16384
    s_add_u32 m0, s39, s48
    s_nop 0
    buffer_load_dwordx4 v236, s[20:23], s37 offen offset:0 lds
    s_add_u32 m0, m0, 832
    s_nop 0
    buffer_load_dwordx4 v236, s[20:23], s37 offen offset:256 lds
    s_add_u32 m0, m0, 832
    s_nop 0
    buffer_load_dwordx4 v236, s[20:23], s37 offen offset:512 lds
    s_add_u32 m0, m0, 832
    s_nop 0
    buffer_load_dwordx4 v236, s[20:23], s37 offen offset:768 lds
    s_add_u32 s37, s37, 16384
    s_branch L_load
L_loadend:
    s_waitcnt vmcnt(0)
L_end:
    s_endpgm
L_rare_1001:
    s_nop 7
    s_nop 7
    v_max3_f32 v238, v112, v113, v114
    v_max3_f32 v238, v238, v115, v116
    v_max3_f32 v238, v238, v117, v118
    v_max3_f32 v238, v238, v119, v120
    v_max3_f32 v238, v238, v121, v122
    v_max3_f32 v238, v238, v123, v124
    v_max3_f32 v238, v238, v125, v126
    v_max_f32 v238, v238, v127
    v_mov_b32 v239, v238
    s_nop 1
    v_permlane32_swap_b32 v238, v239
    s_nop 1
    v_max_f32 v238, v238, v239
    v_ceil_f32 v238, v238
    v_max_f32 v238, 0, v238
    v_exp_f32 v239, -v238
    v_sub_f32 v144, v144, v238
    v_sub_f32 v145, v145, v238
    v_sub_f32 v146, v146, v238
    v_sub_f32 v147, v147, v238
    v_sub_f32 v148, v148, v238
    v_sub_f32 v149, v149, v238
    v_sub_f32 v150, v150, v238
    v_sub_f32 v151, v151, v238
    v_sub_f32 v152, v152, v238
    v_sub_f32 v153, v153, v238
    v_sub_f32 v154, v154, v238
    v_sub_f32 v155, v155, v238
    v_sub_f32 v156, v156, v238
    v_sub_f32 v157, v157, v238
    v_sub_f32 v158, v158, v238
    v_sub_f32 v159, v159, v238
    v_sub_f32 v112, v112, v238
    v_sub_f32 v113, v113, v238
    v_sub_f32 v114, v114, v238
    v_sub_f32 v115, v115, v238
    v_sub_f32 v116, v116, v238
    v_sub_f32 v117, v117, v238
    v_sub_f32 v118, v118, v238
    v_sub_f32 v119, v119, v238
    v_sub_f32 v120, v120, v238
    v_sub_f32 v121, v121, v238
    v_sub_f32 v122, v122, v238
    v_sub_f32 v123, v123, v238
    v_sub_f32 v124, v124, v238
    v_sub_f32 v125, v125, v238
    v_sub_f32 v126, v126, v238
    v_sub_f32 v127, v127, v238
    v_sub_f32 v96, v96, v238
    v_sub_f32 v97, v97, v238
    v_sub_f32 v98, v98, v238
    v_sub_f32 v99, v99, v238
    v_sub_f32 v100, v100, v238
    v_sub_f32 v101, v101, v238
    v_sub_f32 v102, v102, v238
    v_sub_f32 v103, v103, v238
    v_sub_f32 v104, v104, v238
    v_sub_f32 v105, v105, v238
    v_sub_f32 v106, v106, v238
    v_sub_f32 v107, v107, v238
    v_sub_f32 v108, v108, v238
    v_sub_f32 v109, v109, v238
    v_sub_f32 v110, v110, v238
    v_sub_f32 v111, v111, v238
    v_mul_f32 v0, v0, v239
    v_mul_f32 v1, v1, v239
    v_mul_f32 v2, v2, v239
    v_mul_f32 v3, v3, v239
    v_mul_f32 v4, v4, v239
    v_mul_f32 v5, v5, v239
    v_mul_f32 v6, v6, v239
    v_mul_f32 v7, v7, v239
    v_mul_f32 v8, v8, v239
    v_mul_f32 v9, v9, v239
    v_mul_f32 v10, v10, v239
    v_mul_f32 v11, v11, v239
    v_mul_f32 v12, v12, v239
    v_mul_f32 v13, v13, v239
    v_mul_f32 v14, v14, v239
    v_mul_f32 v15, v15, v239
    v_mul_f32 v16, v16, v239
    v_mul_f32 v17, v17, v239
    v_mul_f32 v18, v18, v239
    v_mul_f32 v19, v19, v239
    v_mul_f32 v20, v20, v239
    v_mul_f32 v21, v21, v239
    v_mul_f32 v22, v22, v239
    v_mul_f32 v23, v23, v239
    v_mul_f32 v24, v24, v239
    v_mul_f32 v25, v25, v239
    v_mul_f32 v26, v26, v239
    v_mul_f32 v27, v27, v239
    v_mul_f32 v28, v28, v239
    v_mul_f32 v29, v29, v239
    v_mul_f32 v30, v30, v239
    v_mul_f32 v31, v31, v239
    v_mul_f32 v32, v32, v239
    v_mul_f32 v33, v33, v239
    v_mul_f32 v34, v34, v239
    v_mul_f32 v35, v35, v239
    v_mul_f32 v36, v36, v239
    v_mul_f32 v37, v37, v239
    v_mul_f32 v38, v38, v239
    v_mul_f32 v39, v39, v239
    v_mul_f32 v40, v40, v239
    v_mul_f32 v41, v41, v239
    v_mul_f32 v42, v42, v239
    v_mul_f32 v43, v43, v239
    v_mul_f32 v44, v44, v239
    v_mul_f32 v45, v45, v239
    v_mul_f32 v46, v46, v239
    v_mul_f32 v47, v47, v239
    v_mul_f32 v48, v48, v239
    v_mul_f32 v49, v49, v239
    v_mul_f32 v50, v50, v239
    v_mul_f32 v51, v51, v239
    v_mul_f32 v52, v52, v239
    v_mul_f32 v53, v53, v239
    v_mul_f32 v54, v54, v239
    v_mul_f32 v55, v55, v239
    v_mul_f32 v56, v56, v239
    v_mul_f32 v57, v57, v239
    v_mul_f32 v58, v58, v239
    v_mul_f32 v59, v59, v239
    v_mul_f32 v60, v60, v239
    v_mul_f32 v61, v61, v239
    v_mul_f32 v62, v62, v239
    v_mul_f32 v63, v63, v239
    v_mul_f32 v230, v230, v239
    v_exp_f32 v224, v112
    v_exp_f32 v225, v113
    v_exp_f32 v226, v114
    v_add_f32 v229, v224, v225
    v_cvt_pk_bf16_f32 v136, v224, v225
    v_exp_f32 v227, v115
    v_exp_f32 v224, v116
    v_add_f32 v229, v229, v226
    v_add_f32 v229, v229, v227
    v_cvt_pk_bf16_f32 v137, v226, v227
    v_exp_f32 v225, v117
    v_exp_f32 v226, v118
    v_add_f32 v229, v229, v224
    v_add_f32 v229, v229, v225
    v_cvt_pk_bf16_f32 v138, v224, v225
    v_exp_f32 v227, v119
    v_exp_f32 v224, v120
    v_add_f32 v229, v229, v226
    v_add_f32 v229, v229, v227
    v_cvt_pk_bf16_f32 v139, v226, v227
    v_exp_f32 v225, v121
    v_exp_f32 v226, v122
    v_add_f32 v229, v229, v224
    v_add_f32 v229, v229, v225
    v_cvt_pk_bf16_f32 v140, v224, v225
    v_exp_f32 v227, v123
    v_exp_f32 v224, v124
    v_add_f32 v229, v229, v226
    v_add_f32 v229, v229, v227
    v_cvt_pk_bf16_f32 v141, v226, v227
    v_exp_f32 v225, v125
    v_exp_f32 v226, v126
    v_add_f32 v229, v229, v224
    v_add_f32 v229, v229, v225
    v_cvt_pk_bf16_f32 v142, v224, v225
    v_exp_f32 v227, v127
    v_add_f32 v229, v229, v226
    v_add_f32 v229, v229, v227
    v_cvt_pk_bf16_f32 v143, v226, v227
    v_exp_f32 v224, v96
    v_exp_f32 v225, v97
    v_exp_f32 v226, v98
    v_add_f32 v228, v224, v225
    v_cvt_pk_bf16_f32 v128, v224, v225
    v_exp_f32 v227, v99
    v_add_f32 v228, v228, v226
    v_add_f32 v228, v228, v227
    v_cvt_pk_bf16_f32 v129, v226, v227
    s_nop 1
    s_branch L_rareret_1002
L_rare_1004:
    s_nop 7
    s_nop 7
    v_max3_f32 v238, v96, v97, v98
    v_max3_f32 v238, v238, v99, v100
    v_max3_f32 v238, v238, v101, v102
    v_max3_f32 v238, v238, v103, v104
    v_max3_f32 v238, v238, v105, v106
    v_max3_f32 v238, v238, v107, v108
    v_max3_f32 v238, v238, v109, v110
    v_max_f32 v238, v238, v111
    v_mov_b32 v239, v238
    s_nop 1
    v_permlane32_swap_b32 v238, v239
    s_nop 1
    v_max_f32 v238, v238, v239
    v_ceil_f32 v238, v238
    v_max_f32 v238, 0, v238
    v_exp_f32 v239, -v238
    v_sub_f32 v144, v144, v238
    v_sub_f32 v145, v145, v238
    v_sub_f32 v146, v146, v238
    v_sub_f32 v147, v147, v238
    v_sub_f32 v148, v148, v238
    v_sub_f32 v149, v149, v238
    v_sub_f32 v150, v150, v238
    v_sub_f32 v151, v151, v238
    v_sub_f32 v152, v152, v238
    v_sub_f32 v153, v153, v238
    v_sub_f32 v154, v154, v238
    v_sub_f32 v155, v155, v238
    v_sub_f32 v156, v156, v238
    v_sub_f32 v157, v157, v238
    v_sub_f32 v158, v158, v238
    v_sub_f32 v159, v159, v238
    v_sub_f32 v96, v96, v238
    v_sub_f32 v97, v97, v238
    v_sub_f32 v98, v98, v238
    v_sub_f32 v99, v99, v238
    v_sub_f32 v100, v100, v238
    v_sub_f32 v101, v101, v238
    v_sub_f32 v102, v102, v238
    v_sub_f32 v103, v103, v238
    v_sub_f32 v104, v104, v238
    v_sub_f32 v105, v105, v238
    v_sub_f32 v106, v106, v238
    v_sub_f32 v107, v107, v238
    v_sub_f32 v108, v108, v238
    v_sub_f32 v109, v109, v238
    v_sub_f32 v110, v110, v238
    v_sub_f32 v111, v111, v238
    v_sub_f32 v112, v112, v238
    v_sub_f32 v113, v113, v238
    v_sub_f32 v114, v114, v238
    v_sub_f32 v115, v115, v238
    v_sub_f32 v116, v116, v238
    v_sub_f32 v117, v117, v238
    v_sub_f32 v118, v118, v238
    v_sub_f32 v119, v119, v238
    v_sub_f32 v120, v120, v238
    v_sub_f32 v121, v121, v238
    v_sub_f32 v122, v122, v238
    v_sub_f32 v123, v123, v238
    v_sub_f32 v124, v124, v238
    v_sub_f32 v125, v125, v238
    v_sub_f32 v126, v126, v238
    v_sub_f32 v127, v127, v238
    v_mul_f32 v0, v0, v239
    v_mul_f32 v1, v1, v239
    v_mul_f32 v2, v2, v239
    v_mul_f32 v3, v3, v239
    v_mul_f32 v4, v4, v239
    v_mul_f32 v5, v5, v239
    v_mul_f32 v6, v6, v239
    v_mul_f32 v7, v7, v239
    v_mul_f32 v8, v8, v239
    v_mul_f32 v9, v9, v239
    v_mul_f32 v10, v10, v239
    v_mul_f32 v11, v11, v239
    v_mul_f32 v12, v12, v239
    v_mul_f32 v13, v13, v239
    v_mul_f32 v14, v14, v239
    v_mul_f32 v15, v15, v239
    v_mul_f32 v16, v16, v239
    v_mul_f32 v17, v17, v239
    v_mul_f32 v18, v18, v239
    v_mul_f32 v19, v19, v239
    v_mul_f32 v20, v20, v239
    v_mul_f32 v21, v21, v239
    v_mul_f32 v22, v22, v239
    v_mul_f32 v23, v23, v239
    v_mul_f32 v24, v24, v239
    v_mul_f32 v25, v25, v239
    v_mul_f32 v26, v26, v239
    v_mul_f32 v27, v27, v239
    v_mul_f32 v28, v28, v239
    v_mul_f32 v29, v29, v239
    v_mul_f32 v30, v30, v239
    v_mul_f32 v31, v31, v239
    v_mul_f32 v32, v32, v239
    v_mul_f32 v33, v33, v239
    v_mul_f32 v34, v34, v239
    v_mul_f32 v35, v35, v239
    v_mul_f32 v36, v36, v239
    v_mul_f32 v37, v37, v239
    v_mul_f32 v38, v38, v239
    v_mul_f32 v39, v39, v239
    v_mul_f32 v40, v40, v239
    v_mul_f32 v41, v41, v239
    v_mul_f32 v42, v42, v239
    v_mul_f32 v43, v43, v239
    v_mul_f32 v44, v44, v239
    v_mul_f32 v45, v45, v239
    v_mul_f32 v46, v46, v239
    v_mul_f32 v47, v47, v239
    v_mul_f32 v48, v48, v239
    v_mul_f32 v49, v49, v239
    v_mul_f32 v50, v50, v239
    v_mul_f32 v51, v51, v239
    v_mul_f32 v52, v52, v239
    v_mul_f32 v53, v53, v239
    v_mul_f32 v54, v54, v239
    v_mul_f32 v55, v55, v239
    v_mul_f32 v56, v56, v239
    v_mul_f32 v57, v57, v239
    v_mul_f32 v58, v58, v239
    v_mul_f32 v59, v59, v239
    v_mul_f32 v60, v60, v239
    v_mul_f32 v61, v61, v239
    v_mul_f32 v62, v62, v239
    v_mul_f32 v63, v63, v239
    v_mul_f32 v230, v230, v239
    v_exp_f32 v224, v96
    v_exp_f32 v225, v97
    v_exp_f32 v226, v98
    v_add_f32 v228, v224, v225
    v_cvt_pk_bf16_f32 v128, v224, v225
    v_exp_f32 v227, v99
    v_exp_f32 v224, v100
    v_add_f32 v228, v228, v226
    v_add_f32 v228, v228, v227
    v_cvt_pk_bf16_f32 v129, v226, v227
    v_exp_f32 v225, v101
    v_exp_f32 v226, v102
    v_add_f32 v228, v228, v224
    v_add_f32 v228, v228, v225
    v_cvt_pk_bf16_f32 v130, v224, v225
    v_exp_f32 v227, v103
    v_exp_f32 v224, v104
    v_add_f32 v228, v228, v226
    v_add_f32 v228, v228, v227
    v_cvt_pk_bf16_f32 v131, v226, v227
    v_exp_f32 v225, v105
    v_exp_f32 v226, v106
    v_add_f32 v228, v228, v224
    v_add_f32 v228, v228, v225
    v_cvt_pk_bf16_f32 v132, v224, v225
    v_exp_f32 v227, v107
    v_exp_f32 v224, v108
    v_add_f32 v228, v228, v226
    v_add_f32 v228, v228, v227
    v_cvt_pk_bf16_f32 v133, v226, v227
    v_exp_f32 v225, v109
    v_exp_f32 v226, v110
    v_add_f32 v228, v228, v224
    v_add_f32 v228, v228, v225
    v_cvt_pk_bf16_f32 v134, v224, v225
    v_exp_f32 v227, v111
    v_add_f32 v228, v228, v226
    v_add_f32 v228, v228, v227
    v_cvt_pk_bf16_f32 v135, v226, v227
    v_exp_f32 v224, v112
    v_exp_f32 v225, v113
    v_exp_f32 v226, v114
    v_add_f32 v229, v224, v225
    s_nop 1
    s_branch L_rareret_1005
L_rare_1006:
    s_nop 7
    s_nop 7
    v_max3_f32 v238, v112, v113, v114
    v_max3_f32 v238, v238, v115, v116
    v_max3_f32 v238, v238, v117, v118
    v_max3_f32 v238, v238, v119, v120
    v_max3_f32 v238, v238, v121, v122
    v_max3_f32 v238, v238, v123, v124
    v_max3_f32 v238, v238, v125, v126
    v_max_f32 v238, v238, v127
    v_mov_b32 v239, v238
    s_nop 1
    v_permlane32_swap_b32 v238, v239
    s_nop 1
    v_max_f32 v238, v238, v239
    v_ceil_f32 v238, v238
    v_max_f32 v238, 0, v238
    v_exp_f32 v239, -v238
    v_sub_f32 v144, v144, v238
    v_sub_f32 v145, v145, v238
    v_sub_f32 v146, v146, v238
    v_sub_f32 v147, v147, v238
    v_sub_f32 v148, v148, v238
    v_sub_f32 v149, v149, v238
    v_sub_f32 v150, v150, v238
    v_sub_f32 v151, v151, v238
    v_sub_f32 v152, v152, v238
    v_sub_f32 v153, v153, v238
    v_sub_f32 v154, v154, v238
    v_sub_f32 v155, v155, v238
    v_sub_f32 v156, v156, v238
    v_sub_f32 v157, v157, v238
    v_sub_f32 v158, v158, v238
    v_sub_f32 v159, v159, v238
    v_sub_f32 v112, v112, v238
    v_sub_f32 v113, v113, v238
    v_sub_f32 v114, v114, v238
    v_sub_f32 v115, v115, v238
    v_sub_f32 v116, v116, v238
    v_sub_f32 v117, v117, v238
    v_sub_f32 v118, v118, v238
    v_sub_f32 v119, v119, v238
    v_sub_f32 v120, v120, v238
    v_sub_f32 v121, v121, v238
    v_sub_f32 v122, v122, v238
    v_sub_f32 v123, v123, v238
    v_sub_f32 v124, v124, v238
    v_sub_f32 v125, v125, v238
    v_sub_f32 v126, v126, v238
    v_sub_f32 v127, v127, v238
    v_sub_f32 v96, v96, v238
    v_sub_f32 v97, v97, v238
    v_sub_f32 v98, v98, v238
    v_sub_f32 v99, v99, v238
    v_sub_f32 v100, v100, v238
    v_sub_f32 v101, v101, v238
    v_sub_f32 v102, v102, v238
    v_sub_f32 v103, v103, v238
    v_sub_f32 v104, v104, v238
    v_sub_f32 v105, v105, v238
    v_sub_f32 v106, v106, v238
    v_sub_f32 v107, v107, v238
    v_sub_f32 v108, v108, v238
    v_sub_f32 v109, v109, v238
    v_sub_f32 v110, v110, v238
    v_sub_f32 v111, v111, v238
    v_mul_f32 v0, v0, v239
    v_mul_f32 v1, v1, v239
    v_mul_f32 v2, v2, v239
    v_mul_f32 v3, v3, v239
    v_mul_f32 v4, v4, v239
    v_mul_f32 v5, v5, v239
    v_mul_f32 v6, v6, v239
    v_mul_f32 v7, v7, v239
    v_mul_f32 v8, v8, v239
    v_mul_f32 v9, v9, v239
    v_mul_f32 v10, v10, v239
    v_mul_f32 v11, v11, v239
    v_mul_f32 v12, v12, v239
    v_mul_f32 v13, v13, v239
    v_mul_f32 v14, v14, v239
    v_mul_f32 v15, v15, v239
    v_mul_f32 v16, v16, v239
    v_mul_f32 v17, v17, v239
    v_mul_f32 v18, v18, v239
    v_mul_f32 v19, v19, v239
    v_mul_f32 v20, v20, v239
    v_mul_f32 v21, v21, v239
    v_mul_f32 v22, v22, v239
    v_mul_f32 v23, v23, v239
    v_mul_f32 v24, v24, v239
    v_mul_f32 v25, v25, v239
    v_mul_f32 v26, v26, v239
    v_mul_f32 v27, v27, v239
    v_mul_f32 v28, v28, v239
    v_mul_f32 v29, v29, v239
    v_mul_f32 v30, v30, v239
    v_mul_f32 v31, v31, v239
    v_mul_f32 v32, v32, v239
    v_mul_f32 v33, v33, v239
    v_mul_f32 v34, v34, v239
    v_mul_f32 v35, v35, v239
    v_mul_f32 v36, v36, v239
    v_mul_f32 v37, v37, v239
    v_mul_f32 v38, v38, v239
    v_mul_f32 v39, v39, v239
    v_mul_f32 v40, v40, v239
    v_mul_f32 v41, v41, v239
    v_mul_f32 v42, v42, v239
    v_mul_f32 v43, v43, v239
    v_mul_f32 v44, v44, v239
    v_mul_f32 v45, v45, v239
    v_mul_f32 v46, v46, v239
    v_mul_f32 v47, v47, v239
    v_mul_f32 v48, v48, v239
    v_mul_f32 v49, v49, v239
    v_mul_f32 v50, v50, v239
    v_mul_f32 v51, v51, v239
    v_mul_f32 v52, v52, v239
    v_mul_f32 v53, v53, v239
    v_mul_f32 v54, v54, v239
    v_mul_f32 v55, v55, v239
    v_mul_f32 v56, v56, v239
    v_mul_f32 v57, v57, v239
    v_mul_f32 v58, v58, v239
    v_mul_f32 v59, v59, v239
    v_mul_f32 v60, v60, v239
    v_mul_f32 v61, v61, v239
    v_mul_f32 v62, v62, v239
    v_mul_f32 v63, v63, v239
    v_mul_f32 v230, v230, v239
    v_exp_f32 v224, v112
    v_exp_f32 v225, v113
    v_exp_f32 v226, v114
    v_add_f32 v229, v224, v225
    v_cvt_pk_bf16_f32 v136, v224, v225
    v_exp_f32 v227, v115
    v_exp_f32 v224, v116
    v_add_f32 v229, v229, v226
    v_add_f32 v229, v229, v227
    v_cvt_pk_bf16_f32 v137, v226, v227
    v_exp_f32 v225, v117
    v_exp_f32 v226, v118
    v_add_f32 v229, v229, v224
    v_add_f32 v229, v229, v225
    v_cvt_pk_bf16_f32 v138, v224, v225
    v_exp_f32 v227, v119
    v_exp_f32 v224, v120
    v_add_f32 v229, v229, v226
    v_add_f32 v229, v229, v227
    v_cvt_pk_bf16_f32 v139, v226, v227
    v_exp_f32 v225, v121
    v_exp_f32 v226, v122
    v_add_f32 v229, v229, v224
    v_add_f32 v229, v229, v225
    v_cvt_pk_bf16_f32 v140, v224, v225
    v_exp_f32 v227, v123
    v_exp_f32 v224, v124
    v_add_f32 v229, v229, v226
    v_add_f32 v229, v229, v227
    v_cvt_pk_bf16_f32 v141, v226, v227
    v_exp_f32 v225, v125
    v_exp_f32 v226, v126
    v_add_f32 v229, v229, v224
    v_add_f32 v229, v229, v225
    v_cvt_pk_bf16_f32 v142, v224, v225
    v_exp_f32 v227, v127
    v_add_f32 v229, v229, v226
    v_add_f32 v229, v229, v227
    v_cvt_pk_bf16_f32 v143, v226, v227
    v_exp_f32 v224, v96
    v_exp_f32 v225, v97
    v_exp_f32 v226, v98
    v_add_f32 v228, v224, v225
    v_cvt_pk_bf16_f32 v128, v224, v225
    v_exp_f32 v227, v99
    v_add_f32 v228, v228, v226
    v_add_f32 v228, v228, v227
    v_cvt_pk_bf16_f32 v129, v226, v227
    s_nop 1
    s_branch L_rareret_1007
L_rare_1009:
    s_nop 7
    s_nop 7
    v_max3_f32 v238, v96, v97, v98
    v_max3_f32 v238, v238, v99, v100
    v_max3_f32 v238, v238, v101, v102
    v_max3_f32 v238, v238, v103, v104
    v_max3_f32 v238, v238, v105, v106
    v_max3_f32 v238, v238, v107, v108
    v_max3_f32 v238, v238, v109, v110
    v_max_f32 v238, v238, v111
    v_mov_b32 v239, v238
    s_nop 1
    v_permlane32_swap_b32 v238, v239
    s_nop 1
    v_max_f32 v238, v238, v239
    v_ceil_f32 v238, v238
    v_max_f32 v238, 0, v238
    v_exp_f32 v239, -v238
    v_sub_f32 v144, v144, v238
    v_sub_f32 v145, v145, v238
    v_sub_f32 v146, v146, v238
    v_sub_f32 v147, v147, v238
    v_sub_f32 v148, v148, v238
    v_sub_f32 v149, v149, v238
    v_sub_f32 v150, v150, v238
    v_sub_f32 v151, v151, v238
    v_sub_f32 v152, v152, v238
    v_sub_f32 v153, v153, v238
    v_sub_f32 v154, v154, v238
    v_sub_f32 v155, v155, v238
    v_sub_f32 v156, v156, v238
    v_sub_f32 v157, v157, v238
    v_sub_f32 v158, v158, v238
    v_sub_f32 v159, v159, v238
    v_sub_f32 v96, v96, v238
    v_sub_f32 v97, v97, v238
    v_sub_f32 v98, v98, v238
    v_sub_f32 v99, v99, v238
    v_sub_f32 v100, v100, v238
    v_sub_f32 v101, v101, v238
    v_sub_f32 v102, v102, v238
    v_sub_f32 v103, v103, v238
    v_sub_f32 v104, v104, v238
    v_sub_f32 v105, v105, v238
    v_sub_f32 v106, v106, v238
    v_sub_f32 v107, v107, v238
    v_sub_f32 v108, v108, v238
    v_sub_f32 v109, v109, v238
    v_sub_f32 v110, v110, v238
    v_sub_f32 v111, v111, v238
    v_mul_f32 v0, v0, v239
    v_mul_f32 v1, v1, v239
    v_mul_f32 v2, v2, v239
    v_mul_f32 v3, v3, v239
    v_mul_f32 v4, v4, v239
    v_mul_f32 v5, v5, v239
    v_mul_f32 v6, v6, v239
    v_mul_f32 v7, v7, v239
    v_mul_f32 v8, v8, v239
    v_mul_f32 v9, v9, v239
    v_mul_f32 v10, v10, v239
    v_mul_f32 v11, v11, v239
    v_mul_f32 v12, v12, v239
    v_mul_f32 v13, v13, v239
    v_mul_f32 v14, v14, v239
    v_mul_f32 v15, v15, v239
    v_mul_f32 v16, v16, v239
    v_mul_f32 v17, v17, v239
    v_mul_f32 v18, v18, v239
    v_mul_f32 v19, v19, v239
    v_mul_f32 v20, v20, v239
    v_mul_f32 v21, v21, v239
    v_mul_f32 v22, v22, v239
    v_mul_f32 v23, v23, v239
    v_mul_f32 v24, v24, v239
    v_mul_f32 v25, v25, v239
    v_mul_f32 v26, v26, v239
    v_mul_f32 v27, v27, v239
    v_mul_f32 v28, v28, v239
    v_mul_f32 v29, v29, v239
    v_mul_f32 v30, v30, v239
    v_mul_f32 v31, v31, v239
    v_mul_f32 v32, v32, v239
    v_mul_f32 v33, v33, v239
    v_mul_f32 v34, v34, v239
    v_mul_f32 v35, v35, v239
    v_mul_f32 v36, v36, v239
    v_mul_f32 v37, v37, v239
    v_mul_f32 v38, v38, v239
    v_mul_f32 v39, v39, v239
    v_mul_f32 v40, v40, v239
    v_mul_f32 v41, v41, v239
    v_mul_f32 v42, v42, v239
    v_mul_f32 v43, v43, v239
    v_mul_f32 v44, v44, v239
    v_mul_f32 v45, v45, v239
    v_mul_f32 v46, v46, v239
    v_mul_f32 v47, v47, v239
    v_mul_f32 v48, v48, v239
    v_mul_f32 v49, v49, v239
    v_mul_f32 v50, v50, v239
    v_mul_f32 v51, v51, v239
    v_mul_f32 v52, v52, v239
    v_mul_f32 v53, v53, v239
    v_mul_f32 v54, v54, v239
    v_mul_f32 v55, v55, v239
    v_mul_f32 v56, v56, v239
    v_mul_f32 v57, v57, v239
    v_mul_f32 v58, v58, v239
    v_mul_f32 v59, v59, v239
    v_mul_f32 v60, v60, v239
    v_mul_f32 v61, v61, v239
    v_mul_f32 v62, v62, v239
    v_mul_f32 v63, v63, v239
    v_mul_f32 v230, v230, v239
    v_exp_f32 v224, v96
    v_exp_f32 v225, v97
    v_exp_f32 v226, v98
    v_add_f32 v228, v224, v225
    v_cvt_pk_bf16_f32 v128, v224, v225
    v_exp_f32 v227, v99
    v_exp_f32 v224, v100
    v_add_f32 v228, v228, v226
    v_add_f32 v228, v228, v227
    v_cvt_pk_bf16_f32 v129, v226, v227
    v_exp_f32 v225, v101
    v_exp_f32 v226, v102
    v_add_f32 v228, v228, v224
    v_add_f32 v228, v228, v225
    v_cvt_pk_bf16_f32 v130, v224, v225
    v_exp_f32 v227, v103
    v_exp_f32 v224, v104
    v_add_f32 v228, v228, v226
    v_add_f32 v228, v228, v227
    v_cvt_pk_bf16_f32 v131, v226, v227
    v_exp_f32 v225, v105
    v_exp_f32 v226, v106
    v_add_f32 v228, v228, v224
    v_add_f32 v228, v228, v225
    v_cvt_pk_bf16_f32 v132, v224, v225
    v_exp_f32 v227, v107
    v_exp_f32 v224, v108
    v_add_f32 v228, v228, v226
    v_add_f32 v228, v228, v227
    v_cvt_pk_bf16_f32 v133, v226, v227
    v_exp_f32 v225, v109
    v_exp_f32 v226, v110
    v_add_f32 v228, v228, v224
    v_add_f32 v228, v228, v225
    v_cvt_pk_bf16_f32 v134, v224, v225
    v_exp_f32 v227, v111
    v_add_f32 v228, v228, v226
    v_add_f32 v228, v228, v227
    v_cvt_pk_bf16_f32 v135, v226, v227
    s_nop 1
    s_branch L_rareret_1010
L_rare_1012:
    s_nop 7
    s_nop 7
    v_max3_f32 v238, v96, v97, v98
    v_max3_f32 v238, v238, v99, v100
    v_max3_f32 v238, v238, v101, v102
    v_max3_f32 v238, v238, v103, v104
    v_max3_f32 v238, v238, v105, v106
    v_max3_f32 v238, v238, v107, v108
    v_max3_f32 v238, v238, v109, v110
    v_max_f32 v238, v238, v111
    v_mov_b32 v239, v238
    s_nop 1
    v_permlane32_swap_b32 v238, v239
    s_nop 1
    v_max_f32 v238, v238, v239
    v_ceil_f32 v238, v238
    v_max_f32 v238, 0, v238
    v_exp_f32 v239, -v238
    v_sub_f32 v144, v144, v238
    v_sub_f32 v145, v145, v238
    v_sub_f32 v146, v146, v238
    v_sub_f32 v147, v147, v238
    v_sub_f32 v148, v148, v238
    v_sub_f32 v149, v149, v238
    v_sub_f32 v150, v150, v238
    v_sub_f32 v151, v151, v238
    v_sub_f32 v152, v152, v238
    v_sub_f32 v153, v153, v238
    v_sub_f32 v154, v154, v238
    v_sub_f32 v155, v155, v238
    v_sub_f32 v156, v156, v238
    v_sub_f32 v157, v157, v238
    v_sub_f32 v158, v158, v238
    v_sub_f32 v159, v159, v238
    v_sub_f32 v96, v96, v238
    v_sub_f32 v97, v97, v238
    v_sub_f32 v98, v98, v238
    v_sub_f32 v99, v99, v238
    v_sub_f32 v100, v100, v238
    v_sub_f32 v101, v101, v238
    v_sub_f32 v102, v102, v238
    v_sub_f32 v103, v103, v238
    v_sub_f32 v104, v104, v238
    v_sub_f32 v105, v105, v238
    v_sub_f32 v106, v106, v238
    v_sub_f32 v107, v107, v238
    v_sub_f32 v108, v108, v238
    v_sub_f32 v109, v109, v238
    v_sub_f32 v110, v110, v238
    v_sub_f32 v111, v111, v238
    v_sub_f32 v112, v112, v238
    v_sub_f32 v113, v113, v238
    v_sub_f32 v114, v114, v238
    v_sub_f32 v115, v115, v238
    v_sub_f32 v116, v116, v238
    v_sub_f32 v117, v117, v238
    v_sub_f32 v118, v118, v238
    v_sub_f32 v119, v119, v238
    v_sub_f32 v120, v120, v238
    v_sub_f32 v121, v121, v238
    v_sub_f32 v122, v122, v238
    v_sub_f32 v123, v123, v238
    v_sub_f32 v124, v124, v238
    v_sub_f32 v125, v125, v238
    v_sub_f32 v126, v126, v238
    v_sub_f32 v127, v127, v238
    v_mul_f32 v0, v0, v239
    v_mul_f32 v1, v1, v239
    v_mul_f32 v2, v2, v239
    v_mul_f32 v3, v3, v239
    v_mul_f32 v4, v4, v239
    v_mul_f32 v5, v5, v239
    v_mul_f32 v6, v6, v239
    v_mul_f32 v7, v7, v239
    v_mul_f32 v8, v8, v239
    v_mul_f32 v9, v9, v239
    v_mul_f32 v10, v10, v239
    v_mul_f32 v11, v11, v239
    v_mul_f32 v12, v12, v239
    v_mul_f32 v13, v13, v239
    v_mul_f32 v14, v14, v239
    v_mul_f32 v15, v15, v239
    v_mul_f32 v16, v16, v239
    v_mul_f32 v17, v17, v239
    v_mul_f32 v18, v18, v239
    v_mul_f32 v19, v19, v239
    v_mul_f32 v20, v20, v239
    v_mul_f32 v21, v21, v239
    v_mul_f32 v22, v22, v239
    v_mul_f32 v23, v23, v239
    v_mul_f32 v24, v24, v239
    v_mul_f32 v25, v25, v239
    v_mul_f32 v26, v26, v239
    v_mul_f32 v27, v27, v239
    v_mul_f32 v28, v28, v239
    v_mul_f32 v29, v29, v239
    v_mul_f32 v30, v30, v239
    v_mul_f32 v31, v31, v239
    v_mul_f32 v32, v32, v239
    v_mul_f32 v33, v33, v239
    v_mul_f32 v34, v34, v239
    v_mul_f32 v35, v35, v239
    v_mul_f32 v36, v36, v239
    v_mul_f32 v37, v37, v239
    v_mul_f32 v38, v38, v239
    v_mul_f32 v39, v39, v239
    v_mul_f32 v40, v40, v239
    v_mul_f32 v41, v41, v239
    v_mul_f32 v42, v42, v239
    v_mul_f32 v43, v43, v239
    v_mul_f32 v44, v44, v239
    v_mul_f32 v45, v45, v239
    v_mul_f32 v46, v46, v239
    v_mul_f32 v47, v47, v239
    v_mul_f32 v48, v48, v239
    v_mul_f32 v49, v49, v239
    v_mul_f32 v50, v50, v239
    v_mul_f32 v51, v51, v239
    v_mul_f32 v52, v52, v239
    v_mul_f32 v53, v53, v239
    v_mul_f32 v54, v54, v239
    v_mul_f32 v55, v55, v239
    v_mul_f32 v56, v56, v239
    v_mul_f32 v57, v57, v239
    v_mul_f32 v58, v58, v239
    v_mul_f32 v59, v59, v239
    v_mul_f32 v60, v60, v239
    v_mul_f32 v61, v61, v239
    v_mul_f32 v62, v62, v239
    v_mul_f32 v63, v63, v239
    v_mul_f32 v230, v230, v239
    v_exp_f32 v224, v96
    v_exp_f32 v225, v97
    v_exp_f32 v226, v98
    v_add_f32 v228, v224, v225
    v_cvt_pk_bf16_f32 v128, v224, v225
    v_exp_f32 v227, v99
    v_exp_f32 v224, v100
    v_add_f32 v228, v228, v226
    v_add_f32 v228, v228, v227
    v_cvt_pk_bf16_f32 v129, v226, v227
    v_exp_f32 v225, v101
    v_exp_f32 v226, v102
    v_add_f32 v228, v228, v224
    v_add_f32 v228, v228, v225
    v_cvt_pk_bf16_f32 v130, v224, v225
    v_exp_f32 v227, v103
    v_exp_f32 v224, v104
    v_add_f32 v228, v228, v226
    v_add_f32 v228, v228, v227
    v_cvt_pk_bf16_f32 v131, v226, v227
    v_exp_f32 v225, v105
    v_exp_f32 v226, v106
    v_add_f32 v228, v228, v224
    v_add_f32 v228, v228, v225
    v_cvt_pk_bf16_f32 v132, v224, v225
    v_exp_f32 v227, v107
    v_exp_f32 v224, v108
    v_add_f32 v228, v228, v226
    v_add_f32 v228, v228, v227
    v_cvt_pk_bf16_f32 v133, v226, v227
    v_exp_f32 v225, v109
    v_exp_f32 v226, v110
    v_add_f32 v228, v228, v224
    v_add_f32 v228, v228, v225
    v_cvt_pk_bf16_f32 v134, v224, v225
    v_exp_f32 v227, v111
    v_add_f32 v228, v228, v226
    v_add_f32 v228, v228, v227
    v_cvt_pk_bf16_f32 v135, v226, v227
    v_exp_f32 v224, v112
    v_exp_f32 v225, v113
    v_exp_f32 v226, v114
    v_add_f32 v229, v224, v225
    s_nop 1
    s_branch L_rareret_1013
L_rare_1014:
    s_nop 7
    s_nop 7
    v_max3_f32 v238, v112, v113, v114
    v_max3_f32 v238, v238, v115, v116
    v_max3_f32 v238, v238, v117, v118
    v_max3_f32 v238, v238, v119, v120
    v_max3_f32 v238, v238, v121, v122
    v_max3_f32 v238, v238, v123, v124
    v_max3_f32 v238, v238, v125, v126
    v_max_f32 v238, v238, v127
    v_mov_b32 v239, v238
    s_nop 1
    v_permlane32_swap_b32 v238, v239
    s_nop 1
    v_max_f32 v238, v238, v239
    v_ceil_f32 v238, v238
    v_max_f32 v238, 0, v238
    v_exp_f32 v239, -v238
    v_sub_f32 v144, v144, v238
    v_sub_f32 v145, v145, v238
    v_sub_f32 v146, v146, v238
    v_sub_f32 v147, v147, v238
    v_sub_f32 v148, v148, v238
    v_sub_f32 v149, v149, v238
    v_sub_f32 v150, v150, v238
    v_sub_f32 v151, v151, v238
    v_sub_f32 v152, v152, v238
    v_sub_f32 v153, v153, v238
    v_sub_f32 v154, v154, v238
    v_sub_f32 v155, v155, v238
    v_sub_f32 v156, v156, v238
    v_sub_f32 v157, v157, v238
    v_sub_f32 v158, v158, v238
    v_sub_f32 v159, v159, v238
    v_sub_f32 v112, v112, v238
    v_sub_f32 v113, v113, v238
    v_sub_f32 v114, v114, v238
    v_sub_f32 v115, v115, v238
    v_sub_f32 v116, v116, v238
    v_sub_f32 v117, v117, v238
    v_sub_f32 v118, v118, v238
    v_sub_f32 v119, v119, v238
    v_sub_f32 v120, v120, v238
    v_sub_f32 v121, v121, v238
    v_sub_f32 v122, v122, v238
    v_sub_f32 v123, v123, v238
    v_sub_f32 v124, v124, v238
    v_sub_f32 v125, v125, v238
    v_sub_f32 v126, v126, v238
    v_sub_f32 v127, v127, v238
    v_mul_f32 v0, v0, v239
    v_mul_f32 v1, v1, v239
    v_mul_f32 v2, v2, v239
    v_mul_f32 v3, v3, v239
    v_mul_f32 v4, v4, v239
    v_mul_f32 v5, v5, v239
    v_mul_f32 v6, v6, v239
    v_mul_f32 v7, v7, v239
    v_mul_f32 v8, v8, v239
    v_mul_f32 v9, v9, v239
    v_mul_f32 v10, v10, v239
    v_mul_f32 v11, v11, v239
    v_mul_f32 v12, v12, v239
    v_mul_f32 v13, v13, v239
    v_mul_f32 v14, v14, v239
    v_mul_f32 v15, v15, v239
    v_mul_f32 v16, v16, v239
    v_mul_f32 v17, v17, v239
    v_mul_f32 v18, v18, v239
    v_mul_f32 v19, v19, v239
    v_mul_f32 v20, v20, v239
    v_mul_f32 v21, v21, v239
    v_mul_f32 v22, v22, v239
    v_mul_f32 v23, v23, v239
    v_mul_f32 v24, v24, v239
    v_mul_f32 v25, v25, v239
    v_mul_f32 v26, v26, v239
    v_mul_f32 v27, v27, v239
    v_mul_f32 v28, v28, v239
    v_mul_f32 v29, v29, v239
    v_mul_f32 v30, v30, v239
    v_mul_f32 v31, v31, v239
    v_mul_f32 v32, v32, v239
    v_mul_f32 v33, v33, v239
    v_mul_f32 v34, v34, v239
    v_mul_f32 v35, v35, v239
    v_mul_f32 v36, v36, v239
    v_mul_f32 v37, v37, v239
    v_mul_f32 v38, v38, v239
    v_mul_f32 v39, v39, v239
    v_mul_f32 v40, v40, v239
    v_mul_f32 v41, v41, v239
    v_mul_f32 v42, v42, v239
    v_mul_f32 v43, v43, v239
    v_mul_f32 v44, v44, v239
    v_mul_f32 v45, v45, v239
    v_mul_f32 v46, v46, v239
    v_mul_f32 v47, v47, v239
    v_mul_f32 v48, v48, v239
    v_mul_f32 v49, v49, v239
    v_mul_f32 v50, v50, v239
    v_mul_f32 v51, v51, v239
    v_mul_f32 v52, v52, v239
    v_mul_f32 v53, v53, v239
    v_mul_f32 v54, v54, v239
    v_mul_f32 v55, v55, v239
    v_mul_f32 v56, v56, v239
    v_mul_f32 v57, v57, v239
    v_mul_f32 v58, v58, v239
    v_mul_f32 v59, v59, v239
    v_mul_f32 v60, v60, v239
    v_mul_f32 v61, v61, v239
    v_mul_f32 v62, v62, v239
    v_mul_f32 v63, v63, v239
    v_mul_f32 v230, v230, v239
    v_exp_f32 v224, v112
    v_exp_f32 v225, v113
    v_exp_f32 v226, v114
    v_add_f32 v229, v224, v225
    v_cvt_pk_bf16_f32 v136, v224, v225
    v_exp_f32 v227, v115
    v_exp_f32 v224, v116
    v_add_f32 v229, v229, v226
    v_add_f32 v229, v229, v227
    v_cvt_pk_bf16_f32 v137, v226, v227
    v_exp_f32 v225, v117
    v_exp_f32 v226, v118
    v_add_f32 v229, v229, v224
    v_add_f32 v229, v229, v225
    v_cvt_pk_bf16_f32 v138, v224, v225
    v_exp_f32 v227, v119
    v_exp_f32 v224, v120
    v_add_f32 v229, v229, v226
    v_add_f32 v229, v229, v227
    v_cvt_pk_bf16_f32 v139, v226, v227
    v_exp_f32 v225, v121
    v_exp_f32 v226, v122
    v_add_f32 v229, v229, v224
    v_add_f32 v229, v229, v225
    v_cvt_pk_bf16_f32 v140, v224, v225
    v_exp_f32 v227, v123
    v_exp_f32 v224, v124
    v_add_f32 v229, v229, v226
    v_add_f32 v229, v229, v227
    v_cvt_pk_bf16_f32 v141, v226, v227
    v_exp_f32 v225, v125
    v_exp_f32 v226, v126
    v_add_f32 v229, v229, v224
    v_add_f32 v229, v229, v225
    v_cvt_pk_bf16_f32 v142, v224, v225
    v_exp_f32 v227, v127
    v_add_f32 v229, v229, v226
    v_add_f32 v229, v229, v227
    v_cvt_pk_bf16_f32 v143, v226, v227
    s_nop 1
    s_branch L_rareret_1015
L_rare_1017:
    s_nop 7
    s_nop 7
    v_max3_f32 v238, v112, v113, v114
    v_max3_f32 v238, v238, v115, v116
    v_max3_f32 v238, v238, v117, v118
    v_max3_f32 v238, v238, v119, v120
    v_max3_f32 v238, v238, v121, v122
    v_max3_f32 v238, v238, v123, v124
    v_max3_f32 v238, v238, v125, v126
    v_max_f32 v238, v238, v127
    v_mov_b32 v239, v238
    s_nop 1
    v_permlane32_swap_b32 v238, v239
    s_nop 1
    v_max_f32 v238, v238, v239
    v_ceil_f32 v238, v238
    v_max_f32 v238, 0, v238
    v_exp_f32 v239, -v238
    v_sub_f32 v144, v144, v238
    v_sub_f32 v145, v145, v238
    v_sub_f32 v146, v146, v238
    v_sub_f32 v147, v147, v238
    v_sub_f32 v148, v148, v238
    v_sub_f32 v149, v149, v238
    v_sub_f32 v150, v150, v238
    v_sub_f32 v151, v151, v238
    v_sub_f32 v152, v152, v238
    v_sub_f32 v153, v153, v238
    v_sub_f32 v154, v154, v238
    v_sub_f32 v155, v155, v238
    v_sub_f32 v156, v156, v238
    v_sub_f32 v157, v157, v238
    v_sub_f32 v158, v158, v238
    v_sub_f32 v159, v159, v238
    v_sub_f32 v112, v112, v238
    v_sub_f32 v113, v113, v238
    v_sub_f32 v114, v114, v238
    v_sub_f32 v115, v115, v238
    v_sub_f32 v116, v116, v238
    v_sub_f32 v117, v117, v238
    v_sub_f32 v118, v118, v238
    v_sub_f32 v119, v119, v238
    v_sub_f32 v120, v120, v238
    v_sub_f32 v121, v121, v238
    v_sub_f32 v122, v122, v238
    v_sub_f32 v123, v123, v238
    v_sub_f32 v124, v124, v238
    v_sub_f32 v125, v125, v238
    v_sub_f32 v126, v126, v238
    v_sub_f32 v127, v127, v238
    v_sub_f32 v96, v96, v238
    v_sub_f32 v97, v97, v238
    v_sub_f32 v98, v98, v238
    v_sub_f32 v99, v99, v238
    v_sub_f32 v100, v100, v238
    v_sub_f32 v101, v101, v238
    v_sub_f32 v102, v102, v238
    v_sub_f32 v103, v103, v238
    v_sub_f32 v104, v104, v238
    v_sub_f32 v105, v105, v238
    v_sub_f32 v106, v106, v238
    v_sub_f32 v107, v107, v238
    v_sub_f32 v108, v108, v238
    v_sub_f32 v109, v109, v238
    v_sub_f32 v110, v110, v238
    v_sub_f32 v111, v111, v238
    v_mul_f32 v0, v0, v239
    v_mul_f32 v1, v1, v239
    v_mul_f32 v2, v2, v239
    v_mul_f32 v3, v3, v239
    v_mul_f32 v4, v4, v239
    v_mul_f32 v5, v5, v239
    v_mul_f32 v6, v6, v239
    v_mul_f32 v7, v7, v239
    v_mul_f32 v8, v8, v239
    v_mul_f32 v9, v9, v239
    v_mul_f32 v10, v10, v239
    v_mul_f32 v11, v11, v239
    v_mul_f32 v12, v12, v239
    v_mul_f32 v13, v13, v239
    v_mul_f32 v14, v14, v239
    v_mul_f32 v15, v15, v239
    v_mul_f32 v16, v16, v239
    v_mul_f32 v17, v17, v239
    v_mul_f32 v18, v18, v239
    v_mul_f32 v19, v19, v239
    v_mul_f32 v20, v20, v239
    v_mul_f32 v21, v21, v239
    v_mul_f32 v22, v22, v239
    v_mul_f32 v23, v23, v239
    v_mul_f32 v24, v24, v239
    v_mul_f32 v25, v25, v239
    v_mul_f32 v26, v26, v239
    v_mul_f32 v27, v27, v239
    v_mul_f32 v28, v28, v239
    v_mul_f32 v29, v29, v239
    v_mul_f32 v30, v30, v239
    v_mul_f32 v31, v31, v239
    v_mul_f32 v32, v32, v239
    v_mul_f32 v33, v33, v239
    v_mul_f32 v34, v34, v239
    v_mul_f32 v35, v35, v239
    v_mul_f32 v36, v36, v239
    v_mul_f32 v37, v37, v239
    v_mul_f32 v38, v38, v239
    v_mul_f32 v39, v39, v239
    v_mul_f32 v40, v40, v239
    v_mul_f32 v41, v41, v239
    v_mul_f32 v42, v42, v239
    v_mul_f32 v43, v43, v239
    v_mul_f32 v44, v44, v239
    v_mul_f32 v45, v45, v239
    v_mul_f32 v46, v46, v239
    v_mul_f32 v47, v47, v239
    v_mul_f32 v48, v48, v239
    v_mul_f32 v49, v49, v239
    v_mul_f32 v50, v50, v239
    v_mul_f32 v51, v51, v239
    v_mul_f32 v52, v52, v239
    v_mul_f32 v53, v53, v239
    v_mul_f32 v54, v54, v239
    v_mul_f32 v55, v55, v239
    v_mul_f32 v56, v56, v239
    v_mul_f32 v57, v57, v239
    v_mul_f32 v58, v58, v239
    v_mul_f32 v59, v59, v239
    v_mul_f32 v60, v60, v239
    v_mul_f32 v61, v61, v239
    v_mul_f32 v62, v62, v239
    v_mul_f32 v63, v63, v239
    v_mul_f32 v230, v230, v239
    v_exp_f32 v224, v112
    v_exp_f32 v225, v113
    v_exp_f32 v226, v114
    v_add_f32 v229, v224, v225
    v_cvt_pk_bf16_f32 v136, v224, v225
    v_exp_f32 v227, v115
    v_exp_f32 v224, v116
    v_add_f32 v229, v229, v226
    v_add_f32 v229, v229, v227
    v_cvt_pk_bf16_f32 v137, v226, v227
    v_exp_f32 v225, v117
    v_exp_f32 v226, v118
    v_add_f32 v229, v229, v224
    v_add_f32 v229, v229, v225
    v_cvt_pk_bf16_f32 v138, v224, v225
    v_exp_f32 v227, v119
    v_exp_f32 v224, v120
    v_add_f32 v229, v229, v226
    v_add_f32 v229, v229, v227
    v_cvt_pk_bf16_f32 v139, v226, v227
    v_exp_f32 v225, v121
    v_exp_f32 v226, v122
    v_add_f32 v229, v229, v224
    v_add_f32 v229, v229, v225
    v_cvt_pk_bf16_f32 v140, v224, v225
    v_exp_f32 v227, v123
    v_exp_f32 v224, v124
    v_add_f32 v229, v229, v226
    v_add_f32 v229, v229, v227
    v_cvt_pk_bf16_f32 v141, v226, v227
    v_exp_f32 v225, v125
    v_exp_f32 v226, v126
    v_add_f32 v229, v229, v224
    v_add_f32 v229, v229, v225
    v_cvt_pk_bf16_f32 v142, v224, v225
    v_exp_f32 v227, v127
    v_add_f32 v229, v229, v226
    v_add_f32 v229, v229, v227
    v_cvt_pk_bf16_f32 v143, v226, v227
    v_exp_f32 v224, v96
    v_exp_f32 v225, v97
    v_exp_f32 v226, v98
    v_add_f32 v228, v224, v225
    v_cvt_pk_bf16_f32 v128, v224, v225
    v_exp_f32 v227, v99
    v_add_f32 v228, v228, v226
    v_add_f32 v228, v228, v227
    v_cvt_pk_bf16_f32 v129, v226, v227
    s_nop 1
    s_branch L_rareret_1018
L_rare_1020:
    s_nop 7
    s_nop 7
    v_max3_f32 v238, v96, v97, v98
    v_max3_f32 v238, v238, v99, v100
    v_max3_f32 v238, v238, v101, v102
    v_max3_f32 v238, v238, v103, v104
    v_max3_f32 v238, v238, v105, v106
    v_max3_f32 v238, v238, v107, v108
    v_max3_f32 v238, v238, v109, v110
    v_max_f32 v238, v238, v111
    v_mov_b32 v239, v238
    s_nop 1
    v_permlane32_swap_b32 v238, v239
    s_nop 1
    v_max_f32 v238, v238, v239
    v_ceil_f32 v238, v238
    v_max_f32 v238, 0, v238
    v_exp_f32 v239, -v238
    v_sub_f32 v144, v144, v238
    v_sub_f32 v145, v145, v238
    v_sub_f32 v146, v146, v238
    v_sub_f32 v147, v147, v238
    v_sub_f32 v148, v148, v238
    v_sub_f32 v149, v149, v238
    v_sub_f32 v150, v150, v238
    v_sub_f32 v151, v151, v238
    v_sub_f32 v152, v152, v238
    v_sub_f32 v153, v153, v238
    v_sub_f32 v154, v154, v238
    v_sub_f32 v155, v155, v238
    v_sub_f32 v156, v156, v238
    v_sub_f32 v157, v157, v238
    v_sub_f32 v158, v158, v238
    v_sub_f32 v159, v159, v238
    v_sub_f32 v96, v96, v238
    v_sub_f32 v97, v97, v238
    v_sub_f32 v98, v98, v238
    v_sub_f32 v99, v99, v238
    v_sub_f32 v100, v100, v238
    v_sub_f32 v101, v101, v238
    v_sub_f32 v102, v102, v238
    v_sub_f32 v103, v103, v238
    v_sub_f32 v104, v104, v238
    v_sub_f32 v105, v105, v238
    v_sub_f32 v106, v106, v238
    v_sub_f32 v107, v107, v238
    v_sub_f32 v108, v108, v238
    v_sub_f32 v109, v109, v238
    v_sub_f32 v110, v110, v238
    v_sub_f32 v111, v111, v238
    v_sub_f32 v112, v112, v238
    v_sub_f32 v113, v113, v238
    v_sub_f32 v114, v114, v238
    v_sub_f32 v115, v115, v238
    v_sub_f32 v116, v116, v238
    v_sub_f32 v117, v117, v238
    v_sub_f32 v118, v118, v238
    v_sub_f32 v119, v119, v238
    v_sub_f32 v120, v120, v238
    v_sub_f32 v121, v121, v238
    v_sub_f32 v122, v122, v238
    v_sub_f32 v123, v123, v238
    v_sub_f32 v124, v124, v238
    v_sub_f32 v125, v125, v238
    v_sub_f32 v126, v126, v238
    v_sub_f32 v127, v127, v238
    v_mul_f32 v0, v0, v239
    v_mul_f32 v1, v1, v239
    v_mul_f32 v2, v2, v239
    v_mul_f32 v3, v3, v239
    v_mul_f32 v4, v4, v239
    v_mul_f32 v5, v5, v239
    v_mul_f32 v6, v6, v239
    v_mul_f32 v7, v7, v239
    v_mul_f32 v8, v8, v239
    v_mul_f32 v9, v9, v239
    v_mul_f32 v10, v10, v239
    v_mul_f32 v11, v11, v239
    v_mul_f32 v12, v12, v239
    v_mul_f32 v13, v13, v239
    v_mul_f32 v14, v14, v239
    v_mul_f32 v15, v15, v239
    v_mul_f32 v16, v16, v239
    v_mul_f32 v17, v17, v239
    v_mul_f32 v18, v18, v239
    v_mul_f32 v19, v19, v239
    v_mul_f32 v20, v20, v239
    v_mul_f32 v21, v21, v239
    v_mul_f32 v22, v22, v239
    v_mul_f32 v23, v23, v239
    v_mul_f32 v24, v24, v239
    v_mul_f32 v25, v25, v239
    v_mul_f32 v26, v26, v239
    v_mul_f32 v27, v27, v239
    v_mul_f32 v28, v28, v239
    v_mul_f32 v29, v29, v239
    v_mul_f32 v30, v30, v239
    v_mul_f32 v31, v31, v239
    v_mul_f32 v32, v32, v239
    v_mul_f32 v33, v33, v239
    v_mul_f32 v34, v34, v239
    v_mul_f32 v35, v35, v239
    v_mul_f32 v36, v36, v239
    v_mul_f32 v37, v37, v239
    v_mul_f32 v38, v38, v239
    v_mul_f32 v39, v39, v239
    v_mul_f32 v40, v40, v239
    v_mul_f32 v41, v41, v239
    v_mul_f32 v42, v42, v239
    v_mul_f32 v43, v43, v239
    v_mul_f32 v44, v44, v239
    v_mul_f32 v45, v45, v239
    v_mul_f32 v46, v46, v239
    v_mul_f32 v47, v47, v239
    v_mul_f32 v48, v48, v239
    v_mul_f32 v49, v49, v239
    v_mul_f32 v50, v50, v239
    v_mul_f32 v51, v51, v239
    v_mul_f32 v52, v52, v239
    v_mul_f32 v53, v53, v239
    v_mul_f32 v54, v54, v239
    v_mul_f32 v55, v55, v239
    v_mul_f32 v56, v56, v239
    v_mul_f32 v57, v57, v239
    v_mul_f32 v58, v58, v239
    v_mul_f32 v59, v59, v239
    v_mul_f32 v60, v60, v239
    v_mul_f32 v61, v61, v239
    v_mul_f32 v62, v62, v239
    v_mul_f32 v63, v63, v239
    v_mul_f32 v230, v230, v239
    v_exp_f32 v224, v96
    v_exp_f32 v225, v97
    v_exp_f32 v226, v98
    v_add_f32 v228, v224, v225
    v_cvt_pk_bf16_f32 v128, v224, v225
    v_exp_f32 v227, v99
    v_exp_f32 v224, v100
    v_add_f32 v228, v228, v226
    v_add_f32 v228, v228, v227
    v_cvt_pk_bf16_f32 v129, v226, v227
    v_exp_f32 v225, v101
    v_exp_f32 v226, v102
    v_add_f32 v228, v228, v224
    v_add_f32 v228, v228, v225
    v_cvt_pk_bf16_f32 v130, v224, v225
    v_exp_f32 v227, v103
    v_exp_f32 v224, v104
    v_add_f32 v228, v228, v226
    v_add_f32 v228, v228, v227
    v_cvt_pk_bf16_f32 v131, v226, v227
    v_exp_f32 v225, v105
    v_exp_f32 v226, v106
    v_add_f32 v228, v228, v224
    v_add_f32 v228, v228, v225
    v_cvt_pk_bf16_f32 v132, v224, v225
    v_exp_f32 v227, v107
    v_exp_f32 v224, v108
    v_add_f32 v228, v228, v226
    v_add_f32 v228, v228, v227
    v_cvt_pk_bf16_f32 v133, v226, v227
    v_exp_f32 v225, v109
    v_exp_f32 v226, v110
    v_add_f32 v228, v228, v224
    v_add_f32 v228, v228, v225
    v_cvt_pk_bf16_f32 v134, v224, v225
    v_exp_f32 v227, v111
    v_add_f32 v228, v228, v226
    v_add_f32 v228, v228, v227
    v_cvt_pk_bf16_f32 v135, v226, v227
    v_exp_f32 v224, v112
    v_exp_f32 v225, v113
    v_exp_f32 v226, v114
    v_add_f32 v229, v224, v225
    v_cvt_pk_bf16_f32 v136, v224, v225
    v_exp_f32 v227, v115
    v_add_f32 v229, v229, v226
    v_add_f32 v229, v229, v227
    v_cvt_pk_bf16_f32 v137, v226, v227
    s_nop 1
    s_branch L_rareret_1021
L_rare_1022:
    s_nop 7
    s_nop 7
    v_max3_f32 v238, v112, v113, v114
    v_max3_f32 v238, v238, v115, v116
    v_max3_f32 v238, v238, v117, v118
    v_max3_f32 v238, v238, v119, v120
    v_max3_f32 v238, v238, v121, v122
    v_max3_f32 v238, v238, v123, v124
    v_max3_f32 v238, v238, v125, v126
    v_max_f32 v238, v238, v127
    v_mov_b32 v239, v238
    s_nop 1
    v_permlane32_swap_b32 v238, v239
    s_nop 1
    v_max_f32 v238, v238, v239
    v_ceil_f32 v238, v238
    v_max_f32 v238, 0, v238
    v_exp_f32 v239, -v238
    v_sub_f32 v144, v144, v238
    v_sub_f32 v145, v145, v238
    v_sub_f32 v146, v146, v238
    v_sub_f32 v147, v147, v238
    v_sub_f32 v148, v148, v238
    v_sub_f32 v149, v149, v238
    v_sub_f32 v150, v150, v238
    v_sub_f32 v151, v151, v238
    v_sub_f32 v152, v152, v238
    v_sub_f32 v153, v153, v238
    v_sub_f32 v154, v154, v238
    v_sub_f32 v155, v155, v238
    v_sub_f32 v156, v156, v238
    v_sub_f32 v157, v157, v238
    v_sub_f32 v158, v158, v238
    v_sub_f32 v159, v159, v238
    v_sub_f32 v112, v112, v238
    v_sub_f32 v113, v113, v238
    v_sub_f32 v114, v114, v238
    v_sub_f32 v115, v115, v238
    v_sub_f32 v116, v116, v238
    v_sub_f32 v117, v117, v238
    v_sub_f32 v118, v118, v238
    v_sub_f32 v119, v119, v238
    v_sub_f32 v120, v120, v238
    v_sub_f32 v121, v121, v238
    v_sub_f32 v122, v122, v238
    v_sub_f32 v123, v123, v238
    v_sub_f32 v124, v124, v238
    v_sub_f32 v125, v125, v238
    v_sub_f32 v126, v126, v238
    v_sub_f32 v127, v127, v238
    v_sub_f32 v96, v96, v238
    v_sub_f32 v97, v97, v238
    v_sub_f32 v98, v98, v238
    v_sub_f32 v99, v99, v238
    v_sub_f32 v100, v100, v238
    v_sub_f32 v101, v101, v238
    v_sub_f32 v102, v102, v238
    v_sub_f32 v103, v103, v238
    v_sub_f32 v104, v104, v238
    v_sub_f32 v105, v105, v238
    v_sub_f32 v106, v106, v238
    v_sub_f32 v107, v107, v238
    v_sub_f32 v108, v108, v238
    v_sub_f32 v109, v109, v238
    v_sub_f32 v110, v110, v238
    v_sub_f32 v111, v111, v238
    v_mul_f32 v0, v0, v239
    v_mul_f32 v1, v1, v239
    v_mul_f32 v2, v2, v239
    v_mul_f32 v3, v3, v239
    v_mul_f32 v4, v4, v239
    v_mul_f32 v5, v5, v239
    v_mul_f32 v6, v6, v239
    v_mul_f32 v7, v7, v239
    v_mul_f32 v8, v8, v239
    v_mul_f32 v9, v9, v239
    v_mul_f32 v10, v10, v239
    v_mul_f32 v11, v11, v239
    v_mul_f32 v12, v12, v239
    v_mul_f32 v13, v13, v239
    v_mul_f32 v14, v14, v239
    v_mul_f32 v15, v15, v239
    v_mul_f32 v16, v16, v239
    v_mul_f32 v17, v17, v239
    v_mul_f32 v18, v18, v239
    v_mul_f32 v19, v19, v239
    v_mul_f32 v20, v20, v239
    v_mul_f32 v21, v21, v239
    v_mul_f32 v22, v22, v239
    v_mul_f32 v23, v23, v239
    v_mul_f32 v24, v24, v239
    v_mul_f32 v25, v25, v239
    v_mul_f32 v26, v26, v239
    v_mul_f32 v27, v27, v239
    v_mul_f32 v28, v28, v239
    v_mul_f32 v29, v29, v239
    v_mul_f32 v30, v30, v239
    v_mul_f32 v31, v31, v239
    v_mul_f32 v32, v32, v239
    v_mul_f32 v33, v33, v239
    v_mul_f32 v34, v34, v239
    v_mul_f32 v35, v35, v239
    v_mul_f32 v36, v36, v239
    v_mul_f32 v37, v37, v239
    v_mul_f32 v38, v38, v239
    v_mul_f32 v39, v39, v239
    v_mul_f32 v40, v40, v239
    v_mul_f32 v41, v41, v239
    v_mul_f32 v42, v42, v239
    v_mul_f32 v43, v43, v239
    v_mul_f32 v44, v44, v239
    v_mul_f32 v45, v45, v239
    v_mul_f32 v46, v46, v239
    v_mul_f32 v47, v47, v239
    v_mul_f32 v48, v48, v239
    v_mul_f32 v49, v49, v239
    v_mul_f32 v50, v50, v239
    v_mul_f32 v51, v51, v239
    v_mul_f32 v52, v52, v239
    v_mul_f32 v53, v53, v239
    v_mul_f32 v54, v54, v239
    v_mul_f32 v55, v55, v239
    v_mul_f32 v56, v56, v239
    v_mul_f32 v57, v57, v239
    v_mul_f32 v58, v58, v239
    v_mul_f32 v59, v59, v239
    v_mul_f32 v60, v60, v239
    v_mul_f32 v61, v61, v239
    v_mul_f32 v62, v62, v239
    v_mul_f32 v63, v63, v239
    v_mul_f32 v230, v230, v239
    v_exp_f32 v224, v112
    v_exp_f32 v225, v113
    v_exp_f32 v226, v114
    v_add_f32 v229, v224, v225
    v_cvt_pk_bf16_f32 v136, v224, v225
    v_exp_f32 v227, v115
    v_exp_f32 v224, v116
    v_add_f32 v229, v229, v226
    v_add_f32 v229, v229, v227
    v_cvt_pk_bf16_f32 v137, v226, v227
    v_exp_f32 v225, v117
    v_exp_f32 v226, v118
    v_add_f32 v229, v229, v224
    v_add_f32 v229, v229, v225
    v_cvt_pk_bf16_f32 v138, v224, v225
    v_exp_f32 v227, v119
    v_exp_f32 v224, v120
    v_add_f32 v229, v229, v226
    v_add_f32 v229, v229, v227
    v_cvt_pk_bf16_f32 v139, v226, v227
    v_exp_f32 v225, v121
    v_exp_f32 v226, v122
    v_add_f32 v229, v229, v224
    v_add_f32 v229, v229, v225
    v_cvt_pk_bf16_f32 v140, v224, v225
    v_exp_f32 v227, v123
    v_exp_f32 v224, v124
    v_add_f32 v229, v229, v226
    v_add_f32 v229, v229, v227
    v_cvt_pk_bf16_f32 v141, v226, v227
    v_exp_f32 v225, v125
    v_exp_f32 v226, v126
    v_add_f32 v229, v229, v224
    v_add_f32 v229, v229, v225
    v_cvt_pk_bf16_f32 v142, v224, v225
    v_exp_f32 v227, v127
    v_add_f32 v229, v229, v226
    v_add_f32 v229, v229, v227
    v_cvt_pk_bf16_f32 v143, v226, v227
    v_exp_f32 v224, v96
    v_exp_f32 v225, v97
    v_exp_f32 v226, v98
    v_add_f32 v228, v224, v225
    v_cvt_pk_bf16_f32 v128, v224, v225
    v_exp_f32 v227, v99
    v_add_f32 v228, v228, v226
    v_add_f32 v228, v228, v227
    v_cvt_pk_bf16_f32 v129, v226, v227
    s_nop 1
    s_branch L_rareret_1023
L_rare_1025:
    s_nop 7
    s_nop 7
    v_max3_f32 v238, v96, v97, v98
    v_max3_f32 v238, v238, v99, v100
    v_max3_f32 v238, v238, v101, v102
    v_max3_f32 v238, v238, v103, v104
    v_max3_f32 v238, v238, v105, v106
    v_max3_f32 v238, v238, v107, v108
    v_max3_f32 v238, v238, v109, v110
    v_max_f32 v238, v238, v111
    v_mov_b32 v239, v238
    s_nop 1
    v_permlane32_swap_b32 v238, v239
    s_nop 1
    v_max_f32 v238, v238, v239
    v_ceil_f32 v238, v238
    v_max_f32 v238, 0, v238
    v_exp_f32 v239, -v238
    v_sub_f32 v144, v144, v238
    v_sub_f32 v145, v145, v238
    v_sub_f32 v146, v146, v238
    v_sub_f32 v147, v147, v238
    v_sub_f32 v148, v148, v238
    v_sub_f32 v149, v149, v238
    v_sub_f32 v150, v150, v238
    v_sub_f32 v151, v151, v238
    v_sub_f32 v152, v152, v238
    v_sub_f32 v153, v153, v238
    v_sub_f32 v154, v154, v238
    v_sub_f32 v155, v155, v238
    v_sub_f32 v156, v156, v238
    v_sub_f32 v157, v157, v238
    v_sub_f32 v158, v158, v238
    v_sub_f32 v159, v159, v238
    v_sub_f32 v96, v96, v238
    v_sub_f32 v97, v97, v238
    v_sub_f32 v98, v98, v238
    v_sub_f32 v99, v99, v238
    v_sub_f32 v100, v100, v238
    v_sub_f32 v101, v101, v238
    v_sub_f32 v102, v102, v238
    v_sub_f32 v103, v103, v238
    v_sub_f32 v104, v104, v238
    v_sub_f32 v105, v105, v238
    v_sub_f32 v106, v106, v238
    v_sub_f32 v107, v107, v238
    v_sub_f32 v108, v108, v238
    v_sub_f32 v109, v109, v238
    v_sub_f32 v110, v110, v238
    v_sub_f32 v111, v111, v238
    v_mul_f32 v0, v0, v239
    v_mul_f32 v1, v1, v239
    v_mul_f32 v2, v2, v239
    v_mul_f32 v3, v3, v239
    v_mul_f32 v4, v4, v239
    v_mul_f32 v5, v5, v239
    v_mul_f32 v6, v6, v239
    v_mul_f32 v7, v7, v239
    v_mul_f32 v8, v8, v239
    v_mul_f32 v9, v9, v239
    v_mul_f32 v10, v10, v239
    v_mul_f32 v11, v11, v239
    v_mul_f32 v12, v12, v239
    v_mul_f32 v13, v13, v239
    v_mul_f32 v14, v14, v239
    v_mul_f32 v15, v15, v239
    v_mul_f32 v16, v16, v239
    v_mul_f32 v17, v17, v239
    v_mul_f32 v18, v18, v239
    v_mul_f32 v19, v19, v239
    v_mul_f32 v20, v20, v239
    v_mul_f32 v21, v21, v239
    v_mul_f32 v22, v22, v239
    v_mul_f32 v23, v23, v239
    v_mul_f32 v24, v24, v239
    v_mul_f32 v25, v25, v239
    v_mul_f32 v26, v26, v239
    v_mul_f32 v27, v27, v239
    v_mul_f32 v28, v28, v239
    v_mul_f32 v29, v29, v239
    v_mul_f32 v30, v30, v239
    v_mul_f32 v31, v31, v239
    v_mul_f32 v32, v32, v239
    v_mul_f32 v33, v33, v239
    v_mul_f32 v34, v34, v239
    v_mul_f32 v35, v35, v239
    v_mul_f32 v36, v36, v239
    v_mul_f32 v37, v37, v239
    v_mul_f32 v38, v38, v239
    v_mul_f32 v39, v39, v239
    v_mul_f32 v40, v40, v239
    v_mul_f32 v41, v41, v239
    v_mul_f32 v42, v42, v239
    v_mul_f32 v43, v43, v239
    v_mul_f32 v44, v44, v239
    v_mul_f32 v45, v45, v239
    v_mul_f32 v46, v46, v239
    v_mul_f32 v47, v47, v239
    v_mul_f32 v48, v48, v239
    v_mul_f32 v49, v49, v239
    v_mul_f32 v50, v50, v239
    v_mul_f32 v51, v51, v239
    v_mul_f32 v52, v52, v239
    v_mul_f32 v53, v53, v239
    v_mul_f32 v54, v54, v239
    v_mul_f32 v55, v55, v239
    v_mul_f32 v56, v56, v239
    v_mul_f32 v57, v57, v239
    v_mul_f32 v58, v58, v239
    v_mul_f32 v59, v59, v239
    v_mul_f32 v60, v60, v239
    v_mul_f32 v61, v61, v239
    v_mul_f32 v62, v62, v239
    v_mul_f32 v63, v63, v239
    v_mul_f32 v230, v230, v239
    v_exp_f32 v224, v96
    v_exp_f32 v225, v97
    v_exp_f32 v226, v98
    v_add_f32 v228, v224, v225
    v_cvt_pk_bf16_f32 v128, v224, v225
    v_exp_f32 v227, v99
    v_exp_f32 v224, v100
    v_add_f32 v228, v228, v226
    v_add_f32 v228, v228, v227
    v_cvt_pk_bf16_f32 v129, v226, v227
    v_exp_f32 v225, v101
    v_exp_f32 v226, v102
    v_add_f32 v228, v228, v224
    v_add_f32 v228, v228, v225
    v_cvt_pk_bf16_f32 v130, v224, v225
    v_exp_f32 v227, v103
    v_exp_f32 v224, v104
    v_add_f32 v228, v228, v226
    v_add_f32 v228, v228, v227
    v_cvt_pk_bf16_f32 v131, v226, v227
    v_exp_f32 v225, v105
    v_exp_f32 v226, v106
    v_add_f32 v228, v228, v224
    v_add_f32 v228, v228, v225
    v_cvt_pk_bf16_f32 v132, v224, v225
    v_exp_f32 v227, v107
    v_exp_f32 v224, v108
    v_add_f32 v228, v228, v226
    v_add_f32 v228, v228, v227
    v_cvt_pk_bf16_f32 v133, v226, v227
    v_exp_f32 v225, v109
    v_exp_f32 v226, v110
    v_add_f32 v228, v228, v224
    v_add_f32 v228, v228, v225
    v_cvt_pk_bf16_f32 v134, v224, v225
    v_exp_f32 v227, v111
    v_add_f32 v228, v228, v226
    v_add_f32 v228, v228, v227
    v_cvt_pk_bf16_f32 v135, v226, v227
    s_nop 1
    s_branch L_rareret_1026
L_rare_1028:
    s_nop 7
    s_nop 7
    v_max3_f32 v238, v96, v97, v98
    v_max3_f32 v238, v238, v99, v100
    v_max3_f32 v238, v238, v101, v102
    v_max3_f32 v238, v238, v103, v104
    v_max3_f32 v238, v238, v105, v106
    v_max3_f32 v238, v238, v107, v108
    v_max3_f32 v238, v238, v109, v110
    v_max_f32 v238, v238, v111
    v_mov_b32 v239, v238
    s_nop 1
    v_permlane32_swap_b32 v238, v239
    s_nop 1
    v_max_f32 v238, v238, v239
    v_ceil_f32 v238, v238
    v_max_f32 v238, 0, v238
    v_exp_f32 v239, -v238
    v_sub_f32 v144, v144, v238
    v_sub_f32 v145, v145, v238
    v_sub_f32 v146, v146, v238
    v_sub_f32 v147, v147, v238
    v_sub_f32 v148, v148, v238
    v_sub_f32 v149, v149, v238
    v_sub_f32 v150, v150, v238
    v_sub_f32 v151, v151, v238
    v_sub_f32 v152, v152, v238
    v_sub_f32 v153, v153, v238
    v_sub_f32 v154, v154, v238
    v_sub_f32 v155, v155, v238
    v_sub_f32 v156, v156, v238
    v_sub_f32 v157, v157, v238
    v_sub_f32 v158, v158, v238
    v_sub_f32 v159, v159, v238
    v_sub_f32 v96, v96, v238
    v_sub_f32 v97, v97, v238
    v_sub_f32 v98, v98, v238
    v_sub_f32 v99, v99, v238
    v_sub_f32 v100, v100, v238
    v_sub_f32 v101, v101, v238
    v_sub_f32 v102, v102, v238
    v_sub_f32 v103, v103, v238
    v_sub_f32 v104, v104, v238
    v_sub_f32 v105, v105, v238
    v_sub_f32 v106, v106, v238
    v_sub_f32 v107, v107, v238
    v_sub_f32 v108, v108, v238
    v_sub_f32 v109, v109, v238
    v_sub_f32 v110, v110, v238
    v_sub_f32 v111, v111, v238
    v_sub_f32 v112, v112, v238
    v_sub_f32 v113, v113, v238
    v_sub_f32 v114, v114, v238
    v_sub_f32 v115, v115, v238
    v_sub_f32 v116, v116, v238
    v_sub_f32 v117, v117, v238
    v_sub_f32 v118, v118, v238
    v_sub_f32 v119, v119, v238
    v_sub_f32 v120, v120, v238
    v_sub_f32 v121, v121, v238
    v_sub_f32 v122, v122, v238
    v_sub_f32 v123, v123, v238
    v_sub_f32 v124, v124, v238
    v_sub_f32 v125, v125, v238
    v_sub_f32 v126, v126, v238
    v_sub_f32 v127, v127, v238
    v_mul_f32 v0, v0, v239
    v_mul_f32 v1, v1, v239
    v_mul_f32 v2, v2, v239
    v_mul_f32 v3, v3, v239
    v_mul_f32 v4, v4, v239
    v_mul_f32 v5, v5, v239
    v_mul_f32 v6, v6, v239
    v_mul_f32 v7, v7, v239
    v_mul_f32 v8, v8, v239
    v_mul_f32 v9, v9, v239
    v_mul_f32 v10, v10, v239
    v_mul_f32 v11, v11, v239
    v_mul_f32 v12, v12, v239
    v_mul_f32 v13, v13, v239
    v_mul_f32 v14, v14, v239
    v_mul_f32 v15, v15, v239
    v_mul_f32 v16, v16, v239
    v_mul_f32 v17, v17, v239
    v_mul_f32 v18, v18, v239
    v_mul_f32 v19, v19, v239
    v_mul_f32 v20, v20, v239
    v_mul_f32 v21, v21, v239
    v_mul_f32 v22, v22, v239
    v_mul_f32 v23, v23, v239
    v_mul_f32 v24, v24, v239
    v_mul_f32 v25, v25, v239
    v_mul_f32 v26, v26, v239
    v_mul_f32 v27, v27, v239
    v_mul_f32 v28, v28, v239
    v_mul_f32 v29, v29, v239
    v_mul_f32 v30, v30, v239
    v_mul_f32 v31, v31, v239
    v_mul_f32 v32, v32, v239
    v_mul_f32 v33, v33, v239
    v_mul_f32 v34, v34, v239
    v_mul_f32 v35, v35, v239
    v_mul_f32 v36, v36, v239
    v_mul_f32 v37, v37, v239
    v_mul_f32 v38, v38, v239
    v_mul_f32 v39, v39, v239
    v_mul_f32 v40, v40, v239
    v_mul_f32 v41, v41, v239
    v_mul_f32 v42, v42, v239
    v_mul_f32 v43, v43, v239
    v_mul_f32 v44, v44, v239
    v_mul_f32 v45, v45, v239
    v_mul_f32 v46, v46, v239
    v_mul_f32 v47, v47, v239
    v_mul_f32 v48, v48, v239
    v_mul_f32 v49, v49, v239
    v_mul_f32 v50, v50, v239
    v_mul_f32 v51, v51, v239
    v_mul_f32 v52, v52, v239
    v_mul_f32 v53, v53, v239
    v_mul_f32 v54, v54, v239
    v_mul_f32 v55, v55, v239
    v_mul_f32 v56, v56, v239
    v_mul_f32 v57, v57, v239
    v_mul_f32 v58, v58, v239
    v_mul_f32 v59, v59, v239
    v_mul_f32 v60, v60, v239
    v_mul_f32 v61, v61, v239
    v_mul_f32 v62, v62, v239
    v_mul_f32 v63, v63, v239
    v_mul_f32 v230, v230, v239
    v_exp_f32 v224, v96
    v_exp_f32 v225, v97
    v_exp_f32 v226, v98
    v_add_f32 v228, v224, v225
    v_cvt_pk_bf16_f32 v128, v224, v225
    v_exp_f32 v227, v99
    v_exp_f32 v224, v100
    v_add_f32 v228, v228, v226
    v_add_f32 v228, v228, v227
    v_cvt_pk_bf16_f32 v129, v226, v227
    v_exp_f32 v225, v101
    v_exp_f32 v226, v102
    v_add_f32 v228, v228, v224
    v_add_f32 v228, v228, v225
    v_cvt_pk_bf16_f32 v130, v224, v225
    v_exp_f32 v227, v103
    v_exp_f32 v224, v104
    v_add_f32 v228, v228, v226
    v_add_f32 v228, v228, v227
    v_cvt_pk_bf16_f32 v131, v226, v227
    v_exp_f32 v225, v105
    v_exp_f32 v226, v106
    v_add_f32 v228, v228, v224
    v_add_f32 v228, v228, v225
    v_cvt_pk_bf16_f32 v132, v224, v225
    v_exp_f32 v227, v107
    v_exp_f32 v224, v108
    v_add_f32 v228, v228, v226
    v_add_f32 v228, v228, v227
    v_cvt_pk_bf16_f32 v133, v226, v227
    v_exp_f32 v225, v109
    v_exp_f32 v226, v110
    v_add_f32 v228, v228, v224
    v_add_f32 v228, v228, v225
    v_cvt_pk_bf16_f32 v134, v224, v225
    v_exp_f32 v227, v111
    v_add_f32 v228, v228, v226
    v_add_f32 v228, v228, v227
    v_cvt_pk_bf16_f32 v135, v226, v227
    v_exp_f32 v224, v112
    v_exp_f32 v225, v113
    v_exp_f32 v226, v114
    v_add_f32 v229, v224, v225
    v_cvt_pk_bf16_f32 v136, v224, v225
    v_exp_f32 v227, v115
    v_add_f32 v229, v229, v226
    v_add_f32 v229, v229, v227
    s_nop 1
    s_branch L_rareret_1029
L_rare_1030:
    s_nop 7
    s_nop 7
    v_max3_f32 v238, v112, v113, v114
    v_max3_f32 v238, v238, v115, v116
    v_max3_f32 v238, v238, v117, v118
    v_max3_f32 v238, v238, v119, v120
    v_max3_f32 v238, v238, v121, v122
    v_max3_f32 v238, v238, v123, v124
    v_max3_f32 v238, v238, v125, v126
    v_max_f32 v238, v238, v127
    v_mov_b32 v239, v238
    s_nop 1
    v_permlane32_swap_b32 v238, v239
    s_nop 1
    v_max_f32 v238, v238, v239
    v_ceil_f32 v238, v238
    v_max_f32 v238, 0, v238
    v_exp_f32 v239, -v238
    v_sub_f32 v144, v144, v238
    v_sub_f32 v145, v145, v238
    v_sub_f32 v146, v146, v238
    v_sub_f32 v147, v147, v238
    v_sub_f32 v148, v148, v238
    v_sub_f32 v149, v149, v238
    v_sub_f32 v150, v150, v238
    v_sub_f32 v151, v151, v238
    v_sub_f32 v152, v152, v238
    v_sub_f32 v153, v153, v238
    v_sub_f32 v154, v154, v238
    v_sub_f32 v155, v155, v238
    v_sub_f32 v156, v156, v238
    v_sub_f32 v157, v157, v238
    v_sub_f32 v158, v158, v238
    v_sub_f32 v159, v159, v238
    v_sub_f32 v112, v112, v238
    v_sub_f32 v113, v113, v238
    v_sub_f32 v114, v114, v238
    v_sub_f32 v115, v115, v238
    v_sub_f32 v116, v116, v238
    v_sub_f32 v117, v117, v238
    v_sub_f32 v118, v118, v238
    v_sub_f32 v119, v119, v238
    v_sub_f32 v120, v120, v238
    v_sub_f32 v121, v121, v238
    v_sub_f32 v122, v122, v238
    v_sub_f32 v123, v123, v238
    v_sub_f32 v124, v124, v238
    v_sub_f32 v125, v125, v238
    v_sub_f32 v126, v126, v238
    v_sub_f32 v127, v127, v238
    v_mul_f32 v0, v0, v239
    v_mul_f32 v1, v1, v239
    v_mul_f32 v2, v2, v239
    v_mul_f32 v3, v3, v239
    v_mul_f32 v4, v4, v239
    v_mul_f32 v5, v5, v239
    v_mul_f32 v6, v6, v239
    v_mul_f32 v7, v7, v239
    v_mul_f32 v8, v8, v239
    v_mul_f32 v9, v9, v239
    v_mul_f32 v10, v10, v239
    v_mul_f32 v11, v11, v239
    v_mul_f32 v12, v12, v239
    v_mul_f32 v13, v13, v239
    v_mul_f32 v14, v14, v239
    v_mul_f32 v15, v15, v239
    v_mul_f32 v16, v16, v239
    v_mul_f32 v17, v17, v239
    v_mul_f32 v18, v18, v239
    v_mul_f32 v19, v19, v239
    v_mul_f32 v20, v20, v239
    v_mul_f32 v21, v21, v239
    v_mul_f32 v22, v22, v239
    v_mul_f32 v23, v23, v239
    v_mul_f32 v24, v24, v239
    v_mul_f32 v25, v25, v239
    v_mul_f32 v26, v26, v239
    v_mul_f32 v27, v27, v239
    v_mul_f32 v28, v28, v239
    v_mul_f32 v29, v29, v239
    v_mul_f32 v30, v30, v239
    v_mul_f32 v31, v31, v239
    v_mul_f32 v32, v32, v239
    v_mul_f32 v33, v33, v239
    v_mul_f32 v34, v34, v239
    v_mul_f32 v35, v35, v239
    v_mul_f32 v36, v36, v239
    v_mul_f32 v37, v37, v239
    v_mul_f32 v38, v38, v239
    v_mul_f32 v39, v39, v239
    v_mul_f32 v40, v40, v239
    v_mul_f32 v41, v41, v239
    v_mul_f32 v42, v42, v239
    v_mul_f32 v43, v43, v239
    v_mul_f32 v44, v44, v239
    v_mul_f32 v45, v45, v239
    v_mul_f32 v46, v46, v239
    v_mul_f32 v47, v47, v239
    v_mul_f32 v48, v48, v239
    v_mul_f32 v49, v49, v239
    v_mul_f32 v50, v50, v239
    v_mul_f32 v51, v51, v239
    v_mul_f32 v52, v52, v239
    v_mul_f32 v53, v53, v239
    v_mul_f32 v54, v54, v239
    v_mul_f32 v55, v55, v239
    v_mul_f32 v56, v56, v239
    v_mul_f32 v57, v57, v239
    v_mul_f32 v58, v58, v239
    v_mul_f32 v59, v59, v239
    v_mul_f32 v60, v60, v239
    v_mul_f32 v61, v61, v239
    v_mul_f32 v62, v62, v239
    v_mul_f32 v63, v63, v239
    v_mul_f32 v230, v230, v239
    v_exp_f32 v224, v112
    v_exp_f32 v225, v113
    v_exp_f32 v226, v114
    v_add_f32 v229, v224, v225
    v_cvt_pk_bf16_f32 v136, v224, v225
    v_exp_f32 v227, v115
    v_exp_f32 v224, v116
    v_add_f32 v229, v229, v226
    v_add_f32 v229, v229, v227
    v_cvt_pk_bf16_f32 v137, v226, v227
    v_exp_f32 v225, v117
    v_exp_f32 v226, v118
    v_add_f32 v229, v229, v224
    v_add_f32 v229, v229, v225
    v_cvt_pk_bf16_f32 v138, v224, v225
    v_exp_f32 v227, v119
    v_exp_f32 v224, v120
    v_add_f32 v229, v229, v226
    v_add_f32 v229, v229, v227
    v_cvt_pk_bf16_f32 v139, v226, v227
    v_exp_f32 v225, v121
    v_exp_f32 v226, v122
    v_add_f32 v229, v229, v224
    v_add_f32 v229, v229, v225
    v_cvt_pk_bf16_f32 v140, v224, v225
    v_exp_f32 v227, v123
    v_exp_f32 v224, v124
    v_add_f32 v229, v229, v226
    v_add_f32 v229, v229, v227
    v_cvt_pk_bf16_f32 v141, v226, v227
    v_exp_f32 v225, v125
    v_exp_f32 v226, v126
    v_add_f32 v229, v229, v224
    v_add_f32 v229, v229, v225
    v_cvt_pk_bf16_f32 v142, v224, v225
    v_exp_f32 v227, v127
    v_add_f32 v229, v229, v226
    v_add_f32 v229, v229, v227
    v_cvt_pk_bf16_f32 v143, v226, v227
    s_nop 1
    s_branch L_rareret_1031
    s_endpgm
.section .rodata,"a"
.p2align 6
.amdhsa_kernel standalone__softmax_full_causal__prompt_kernel
  .amdhsa_next_free_vgpr 256
  .amdhsa_next_free_sgpr 102
  .amdhsa_accum_offset 256
  .amdhsa_group_segment_fixed_size 0
  .amdhsa_kernarg_size 48
  .amdhsa_user_sgpr_count 2
  .amdhsa_user_sgpr_kernarg_segment_ptr 1
  .amdhsa_system_sgpr_workgroup_id_x 1
.end_amdhsa_kernel
```
